```python
import torch

def _softmax(x, axis=-1):
    return torch.softmax(x, dim=axis)
def _gelu(x):
    return torch.nn.functional.gelu(x, approximate="tanh")
def _silu(x):
    return torch.nn.functional.silu(x)
def _sigmoid(x):
    return torch.sigmoid(x)
def _layernorm(x, axis=-1, eps=1e-5):
    m = x.mean(dim=axis, keepdim=True)
    v = x.var(dim=axis, keepdim=True, unbiased=False)
    return (x - m) / torch.sqrt(v + eps)
def _scatter_add(tgt, idx, src, axis=0):
    return tgt.clone().index_add_(axis, idx, src)
def _segment_sum(src, seg, n):
    out = torch.zeros((n,) + src.shape[1:], dtype=src.dtype)
    return out.index_add_(0, seg, src)
def _pad(x, pw):
    flat = tuple(v for pair in reversed(pw) for v in pair)
    return torch.nn.functional.pad(x, flat)

kernel_name = 'sequential_preLN__ssm_conv_s4__moe_arch_mod__prompt'

def setup_inputs():

    _w = (lambda a: (lambda t: t.to(torch.bfloat16) if t.is_floating_point() else t)(torch.as_tensor(a)))
    def _A_setup():
        B, L, D, N = 1, 2048, 640, 192
        A_re = -(lambda _x: torch.exp(torch.as_tensor(_x)))((lambda *s: torch.randn(*s, dtype=torch.bfloat16) * 6.4)(D, N))
        A_im = torch.pi * (lambda *s: torch.randn(*s, dtype=torch.bfloat16) * 0.05)(D, N)
        B_re = (lambda *s: torch.randn(*s, dtype=torch.bfloat16) * 0.05)(D, N)
        B_im = (lambda *s: torch.randn(*s, dtype=torch.bfloat16) * 0.05)(D, N)
        C_re = (lambda *s: torch.randn(*s, dtype=torch.bfloat16) * 0.05)(D, N)
        C_im = (lambda *s: torch.randn(*s, dtype=torch.bfloat16) * 0.05)(D, N)
        log_dt = (lambda *s: torch.randn(*s, dtype=torch.bfloat16) * 0.05)(D) * 0.5 - 4.0
        Dskip = (lambda *s: torch.randn(*s, dtype=torch.bfloat16) * 0.05)(D)
        return {
            "u": _w((lambda *s: torch.randn(*s, dtype=torch.bfloat16) * 0.05)(B, L, D)),
            "A_re": _w(A_re),
            "A_im": _w(A_im),
            "B_re": _w(B_re),
            "B_im": _w(B_im),
            "C_re": _w(C_re),
            "C_im": _w(C_im),
            "log_dt": _w(log_dt),
            "Dskip": _w(Dskip),
        }
    _A_in = _A_setup()

    def _B_setup():
        B, S, D, F, C = 1, 2048, 640, 1536, 1
        return {
            "x": _w((lambda *s: torch.randn(*s, dtype=torch.bfloat16) * 0.05)(B, S, D)),
            "w_r": _w((lambda *s: torch.randn(*s, dtype=torch.bfloat16) * 0.05)(D)),
            "w_gate": _w((lambda *s: torch.randn(*s, dtype=torch.bfloat16) * 0.05)(D, F)),
            "w_up": _w((lambda *s: torch.randn(*s, dtype=torch.bfloat16) * 0.05)(D, F)),
            "w_down": _w((lambda *s: torch.randn(*s, dtype=torch.bfloat16) * 0.05)(F, D)),
        }
    _B_in = _B_setup()

    return {
        "A_u": _A_in["u"],
        "A_A_re": _A_in["A_re"],
        "A_A_im": _A_in["A_im"],
        "A_B_re": _A_in["B_re"],
        "A_B_im": _A_in["B_im"],
        "A_C_re": _A_in["C_re"],
        "A_C_im": _A_in["C_im"],
        "A_log_dt": _A_in["log_dt"],
        "A_Dskip": _A_in["Dskip"],
        "B_x": _B_in["x"],
        "B_w_r": _B_in["w_r"],
        "B_w_gate": _B_in["w_gate"],
        "B_w_up": _B_in["w_up"],
        "B_w_down": _B_in["w_down"],
    }

def reference(A_u, A_A_re, A_A_im, A_B_re, A_B_im, A_C_re, A_C_im, A_log_dt, A_Dskip, B_x, B_w_r, B_w_gate, B_w_up, B_w_down):
    def _A_ref(u, A_re, A_im, B_re, B_im, C_re, C_im, log_dt, Dskip):
        Bsz, L, D = u.shape
        dt = torch.exp(log_dt)[:, None]
        A = A_re + 1j * A_im
        Bc = B_re + 1j * B_im
        Cc = C_re + 1j * C_im
        logdA = dt * A
        dB = dt * Bc
        l = (lambda x, dt: x.to(dt))(torch.arange(L), A_re.dtype)
        P = torch.exp(logdA[:, :, None] * l[None, None, :])
        K = torch.einsum("dn,dnl,dn->dl", Cc, P, dB).real
        L2 = 2 * L
        Kp = _pad(K, ((0, 0), (0, L)))
        up = (lambda x, *d: x.permute(*d))(u, 0, 2, 1)
        up = _pad(up, ((0, 0), (0, 0), (0, L)))
        Kf = (lambda x, axes=(-2,-1): torch.fft.rfft2(x.float(), dim=axes))(Kp[:, None, :], axes=(-2, -1))
        Uf = (lambda x, axes=(-2,-1): torch.fft.rfft2(x.float(), dim=axes))(up[:, :, None, :], axes=(-2, -1))
        Yf = Uf * Kf[None, :, :, :]
        y = (lambda x, s, axes=(-2,-1): torch.fft.irfft2(x, s=s, dim=axes).to(torch.bfloat16))(Yf, (1, L2), axes=(-2, -1))[:, :, 0, :L]
        y = (lambda x, *d: x.permute(*d))(y, 0, 2, 1) + u * Dskip[None, None, :]
        return y

    def _B_ref(x, w_r, w_gate, w_up, w_down):
        B, S, D = x.shape
        C = 1
        r = x @ w_r
        idx = torch.argsort(-r, axis=-1)[:, :C]
        idx_e = (lambda x, n, axis: torch.repeat_interleave(x, n, dim=axis))(idx.reshape(B, C, 1), D, axis=2)
        x_sel = (lambda x, i, axis: torch.take_along_dim(x, i, dim=axis))(x, idx_e, axis=1)
        g = _silu(x_sel @ w_gate)
        u = x_sel @ w_up
        y = (g * u) @ w_down
        r_sel = _sigmoid((lambda x, i, axis: torch.take_along_dim(x, i, dim=axis))(r, idx, axis=1))
        y = y * r_sel.reshape(B, C, 1)
        b_off = (torch.arange(B) * S).reshape(B, 1)
        flat_idx = (idx + b_off).reshape(B * C)
        zero = (x * 0.0).reshape(B * S, D)
        upd = _scatter_add(zero, flat_idx, y.reshape(B * C, D), axis=0)
        return x + upd.reshape(B, S, D)

    x = A_u
    h = x + _A_ref(_layernorm(x, axis=-1), A_A_re, A_A_im, A_B_re, A_B_im, A_C_re, A_C_im, A_log_dt, A_Dskip)
    h2 = h + _B_ref(_layernorm(h, axis=-1), B_w_r, B_w_gate, B_w_up, B_w_down)
    return h2
```

```asm
; @launch kernel=ka_kernel grid=(896,1,1) block=(320,1,1) lds=37760
; @launch kernel=kb_kernel grid=(352,1,1) block=(320,1,1) lds=4096
.amdgcn_target "amdgcn-amd-amdhsa--gfx950"
.text
.globl ka_kernel
.p2align 8
.type ka_kernel,@function
ka_kernel:
  s_cmp_ge_u32 s2, 896
  s_cbranch_scc1 KA_END
  s_load_dwordx2 s[6:7], s[0:1], 128
  s_load_dwordx2 s[60:61], s[0:1], 120
  s_cmp_ge_u32 s2, 256
  s_cbranch_scc1 KA_KGEN
  s_load_dwordx2 s[4:5], s[0:1], 0
  v_lshrrev_b32 v63, 6, v0
  s_nop 0
  v_readfirstlane_b32 s8, v63
  v_and_b32 v1, 63, v0
  s_mul_i32 s3, s2, 10240
  v_lshlrev_b32 v2, 2, v0
  v_add_u32 v2, s3, v2
  v_add_u32 v3, 5120, v2
  s_waitcnt lgkmcnt(0)
  global_load_dword v4, v2, s[4:5] offset:0
  global_load_dword v5, v2, s[4:5] offset:1280
  global_load_dword v6, v2, s[4:5] offset:2560
  global_load_dword v7, v2, s[4:5] offset:3840
  global_load_dword v8, v3, s[4:5] offset:0
  global_load_dword v9, v3, s[4:5] offset:1280
  global_load_dword v10, v3, s[4:5] offset:2560
  global_load_dword v11, v3, s[4:5] offset:3840
  s_waitcnt vmcnt(0)
  v_lshlrev_b32 v12, 16, v4
  v_and_b32 v13, 0xffff0000, v4
  v_lshlrev_b32 v14, 16, v5
  v_and_b32 v15, 0xffff0000, v5
  v_lshlrev_b32 v16, 16, v6
  v_and_b32 v17, 0xffff0000, v6
  v_lshlrev_b32 v18, 16, v7
  v_and_b32 v19, 0xffff0000, v7
  v_lshlrev_b32 v20, 16, v8
  v_and_b32 v21, 0xffff0000, v8
  v_lshlrev_b32 v22, 16, v9
  v_and_b32 v23, 0xffff0000, v9
  v_lshlrev_b32 v24, 16, v10
  v_and_b32 v25, 0xffff0000, v10
  v_lshlrev_b32 v26, 16, v11
  v_and_b32 v27, 0xffff0000, v11
  v_add_f32 v28, v12, v13
  v_add_f32 v29, v14, v15
  v_add_f32 v30, v16, v17
  v_add_f32 v31, v18, v19
  v_add_f32 v32, v20, v21
  v_add_f32 v33, v22, v23
  v_add_f32 v34, v24, v25
  v_add_f32 v35, v26, v27
  v_add_f32_dpp v28, v28, v28 row_shr:1 row_mask:0xf bank_mask:0xf bound_ctrl:0
  v_add_f32_dpp v29, v29, v29 row_shr:1 row_mask:0xf bank_mask:0xf bound_ctrl:0
  v_add_f32_dpp v30, v30, v30 row_shr:1 row_mask:0xf bank_mask:0xf bound_ctrl:0
  v_add_f32_dpp v31, v31, v31 row_shr:1 row_mask:0xf bank_mask:0xf bound_ctrl:0
  v_add_f32_dpp v32, v32, v32 row_shr:1 row_mask:0xf bank_mask:0xf bound_ctrl:0
  v_add_f32_dpp v33, v33, v33 row_shr:1 row_mask:0xf bank_mask:0xf bound_ctrl:0
  v_add_f32_dpp v34, v34, v34 row_shr:1 row_mask:0xf bank_mask:0xf bound_ctrl:0
  v_add_f32_dpp v35, v35, v35 row_shr:1 row_mask:0xf bank_mask:0xf bound_ctrl:0
  v_add_f32_dpp v28, v28, v28 row_shr:2 row_mask:0xf bank_mask:0xf bound_ctrl:0
  v_add_f32_dpp v29, v29, v29 row_shr:2 row_mask:0xf bank_mask:0xf bound_ctrl:0
  v_add_f32_dpp v30, v30, v30 row_shr:2 row_mask:0xf bank_mask:0xf bound_ctrl:0
  v_add_f32_dpp v31, v31, v31 row_shr:2 row_mask:0xf bank_mask:0xf bound_ctrl:0
  v_add_f32_dpp v32, v32, v32 row_shr:2 row_mask:0xf bank_mask:0xf bound_ctrl:0
  v_add_f32_dpp v33, v33, v33 row_shr:2 row_mask:0xf bank_mask:0xf bound_ctrl:0
  v_add_f32_dpp v34, v34, v34 row_shr:2 row_mask:0xf bank_mask:0xf bound_ctrl:0
  v_add_f32_dpp v35, v35, v35 row_shr:2 row_mask:0xf bank_mask:0xf bound_ctrl:0
  v_add_f32_dpp v28, v28, v28 row_shr:4 row_mask:0xf bank_mask:0xf bound_ctrl:0
  v_add_f32_dpp v29, v29, v29 row_shr:4 row_mask:0xf bank_mask:0xf bound_ctrl:0
  v_add_f32_dpp v30, v30, v30 row_shr:4 row_mask:0xf bank_mask:0xf bound_ctrl:0
  v_add_f32_dpp v31, v31, v31 row_shr:4 row_mask:0xf bank_mask:0xf bound_ctrl:0
  v_add_f32_dpp v32, v32, v32 row_shr:4 row_mask:0xf bank_mask:0xf bound_ctrl:0
  v_add_f32_dpp v33, v33, v33 row_shr:4 row_mask:0xf bank_mask:0xf bound_ctrl:0
  v_add_f32_dpp v34, v34, v34 row_shr:4 row_mask:0xf bank_mask:0xf bound_ctrl:0
  v_add_f32_dpp v35, v35, v35 row_shr:4 row_mask:0xf bank_mask:0xf bound_ctrl:0
  v_add_f32_dpp v28, v28, v28 row_shr:8 row_mask:0xf bank_mask:0xf bound_ctrl:0
  v_add_f32_dpp v29, v29, v29 row_shr:8 row_mask:0xf bank_mask:0xf bound_ctrl:0
  v_add_f32_dpp v30, v30, v30 row_shr:8 row_mask:0xf bank_mask:0xf bound_ctrl:0
  v_add_f32_dpp v31, v31, v31 row_shr:8 row_mask:0xf bank_mask:0xf bound_ctrl:0
  v_add_f32_dpp v32, v32, v32 row_shr:8 row_mask:0xf bank_mask:0xf bound_ctrl:0
  v_add_f32_dpp v33, v33, v33 row_shr:8 row_mask:0xf bank_mask:0xf bound_ctrl:0
  v_add_f32_dpp v34, v34, v34 row_shr:8 row_mask:0xf bank_mask:0xf bound_ctrl:0
  v_add_f32_dpp v35, v35, v35 row_shr:8 row_mask:0xf bank_mask:0xf bound_ctrl:0
  v_add_f32_dpp v28, v28, v28 row_bcast:15 row_mask:0xa bank_mask:0xf
  v_add_f32_dpp v29, v29, v29 row_bcast:15 row_mask:0xa bank_mask:0xf
  v_add_f32_dpp v30, v30, v30 row_bcast:15 row_mask:0xa bank_mask:0xf
  v_add_f32_dpp v31, v31, v31 row_bcast:15 row_mask:0xa bank_mask:0xf
  v_add_f32_dpp v32, v32, v32 row_bcast:15 row_mask:0xa bank_mask:0xf
  v_add_f32_dpp v33, v33, v33 row_bcast:15 row_mask:0xa bank_mask:0xf
  v_add_f32_dpp v34, v34, v34 row_bcast:15 row_mask:0xa bank_mask:0xf
  v_add_f32_dpp v35, v35, v35 row_bcast:15 row_mask:0xa bank_mask:0xf
  v_add_f32_dpp v28, v28, v28 row_bcast:31 row_mask:0xc bank_mask:0xf
  v_add_f32_dpp v29, v29, v29 row_bcast:31 row_mask:0xc bank_mask:0xf
  v_add_f32_dpp v30, v30, v30 row_bcast:31 row_mask:0xc bank_mask:0xf
  v_add_f32_dpp v31, v31, v31 row_bcast:31 row_mask:0xc bank_mask:0xf
  v_add_f32_dpp v32, v32, v32 row_bcast:31 row_mask:0xc bank_mask:0xf
  v_add_f32_dpp v33, v33, v33 row_bcast:31 row_mask:0xc bank_mask:0xf
  v_add_f32_dpp v34, v34, v34 row_bcast:31 row_mask:0xc bank_mask:0xf
  v_add_f32_dpp v35, v35, v35 row_bcast:31 row_mask:0xc bank_mask:0xf
  s_lshl_b32 s9, s8, 5
  v_mov_b32 v37, s9
  s_mov_b32 exec_lo, 0
  s_mov_b32 exec_hi, 0x80000000
  ds_write_b128 v37, v[28:31] offset:0
  ds_write_b128 v37, v[32:35] offset:16
  s_mov_b64 exec, -1
  s_waitcnt lgkmcnt(0)
  s_barrier
  v_and_b32 v37, 7, v1
  v_lshlrev_b32 v37, 2, v37
  ds_read_b32 v28, v37 offset:0
  ds_read_b32 v29, v37 offset:32
  ds_read_b32 v30, v37 offset:64
  ds_read_b32 v31, v37 offset:96
  ds_read_b32 v32, v37 offset:128
  s_waitcnt lgkmcnt(0)
  v_add_f32 v36, v28, v29
  v_add_f32 v36, v36, v30
  v_add_f32 v36, v36, v31
  v_add_f32 v36, v36, v32
  v_mul_f32 v36, 0x3acccccd, v36
  s_nop 0
  v_readlane_b32 s16, v36, 0
  v_readlane_b32 s17, v36, 1
  v_readlane_b32 s18, v36, 2
  v_readlane_b32 s19, v36, 3
  v_readlane_b32 s20, v36, 4
  v_readlane_b32 s21, v36, 5
  v_readlane_b32 s22, v36, 6
  v_readlane_b32 s23, v36, 7
  v_subrev_f32 v38, s16, v12
  v_subrev_f32 v39, s16, v13
  v_mul_f32 v28, v38, v38
  v_fmac_f32 v28, v39, v39
  v_subrev_f32 v38, s17, v14
  v_subrev_f32 v39, s17, v15
  v_mul_f32 v29, v38, v38
  v_fmac_f32 v29, v39, v39
  v_subrev_f32 v38, s18, v16
  v_subrev_f32 v39, s18, v17
  v_mul_f32 v30, v38, v38
  v_fmac_f32 v30, v39, v39
  v_subrev_f32 v38, s19, v18
  v_subrev_f32 v39, s19, v19
  v_mul_f32 v31, v38, v38
  v_fmac_f32 v31, v39, v39
  v_subrev_f32 v38, s20, v20
  v_subrev_f32 v39, s20, v21
  v_mul_f32 v32, v38, v38
  v_fmac_f32 v32, v39, v39
  v_subrev_f32 v38, s21, v22
  v_subrev_f32 v39, s21, v23
  v_mul_f32 v33, v38, v38
  v_fmac_f32 v33, v39, v39
  v_subrev_f32 v38, s22, v24
  v_subrev_f32 v39, s22, v25
  v_mul_f32 v34, v38, v38
  v_fmac_f32 v34, v39, v39
  v_subrev_f32 v38, s23, v26
  v_subrev_f32 v39, s23, v27
  v_mul_f32 v35, v38, v38
  v_fmac_f32 v35, v39, v39
  v_add_f32_dpp v28, v28, v28 row_shr:1 row_mask:0xf bank_mask:0xf bound_ctrl:0
  v_add_f32_dpp v29, v29, v29 row_shr:1 row_mask:0xf bank_mask:0xf bound_ctrl:0
  v_add_f32_dpp v30, v30, v30 row_shr:1 row_mask:0xf bank_mask:0xf bound_ctrl:0
  v_add_f32_dpp v31, v31, v31 row_shr:1 row_mask:0xf bank_mask:0xf bound_ctrl:0
  v_add_f32_dpp v32, v32, v32 row_shr:1 row_mask:0xf bank_mask:0xf bound_ctrl:0
  v_add_f32_dpp v33, v33, v33 row_shr:1 row_mask:0xf bank_mask:0xf bound_ctrl:0
  v_add_f32_dpp v34, v34, v34 row_shr:1 row_mask:0xf bank_mask:0xf bound_ctrl:0
  v_add_f32_dpp v35, v35, v35 row_shr:1 row_mask:0xf bank_mask:0xf bound_ctrl:0
  v_add_f32_dpp v28, v28, v28 row_shr:2 row_mask:0xf bank_mask:0xf bound_ctrl:0
  v_add_f32_dpp v29, v29, v29 row_shr:2 row_mask:0xf bank_mask:0xf bound_ctrl:0
  v_add_f32_dpp v30, v30, v30 row_shr:2 row_mask:0xf bank_mask:0xf bound_ctrl:0
  v_add_f32_dpp v31, v31, v31 row_shr:2 row_mask:0xf bank_mask:0xf bound_ctrl:0
  v_add_f32_dpp v32, v32, v32 row_shr:2 row_mask:0xf bank_mask:0xf bound_ctrl:0
  v_add_f32_dpp v33, v33, v33 row_shr:2 row_mask:0xf bank_mask:0xf bound_ctrl:0
  v_add_f32_dpp v34, v34, v34 row_shr:2 row_mask:0xf bank_mask:0xf bound_ctrl:0
  v_add_f32_dpp v35, v35, v35 row_shr:2 row_mask:0xf bank_mask:0xf bound_ctrl:0
  v_add_f32_dpp v28, v28, v28 row_shr:4 row_mask:0xf bank_mask:0xf bound_ctrl:0
  v_add_f32_dpp v29, v29, v29 row_shr:4 row_mask:0xf bank_mask:0xf bound_ctrl:0
  v_add_f32_dpp v30, v30, v30 row_shr:4 row_mask:0xf bank_mask:0xf bound_ctrl:0
  v_add_f32_dpp v31, v31, v31 row_shr:4 row_mask:0xf bank_mask:0xf bound_ctrl:0
  v_add_f32_dpp v32, v32, v32 row_shr:4 row_mask:0xf bank_mask:0xf bound_ctrl:0
  v_add_f32_dpp v33, v33, v33 row_shr:4 row_mask:0xf bank_mask:0xf bound_ctrl:0
  v_add_f32_dpp v34, v34, v34 row_shr:4 row_mask:0xf bank_mask:0xf bound_ctrl:0
  v_add_f32_dpp v35, v35, v35 row_shr:4 row_mask:0xf bank_mask:0xf bound_ctrl:0
  v_add_f32_dpp v28, v28, v28 row_shr:8 row_mask:0xf bank_mask:0xf bound_ctrl:0
  v_add_f32_dpp v29, v29, v29 row_shr:8 row_mask:0xf bank_mask:0xf bound_ctrl:0
  v_add_f32_dpp v30, v30, v30 row_shr:8 row_mask:0xf bank_mask:0xf bound_ctrl:0
  v_add_f32_dpp v31, v31, v31 row_shr:8 row_mask:0xf bank_mask:0xf bound_ctrl:0
  v_add_f32_dpp v32, v32, v32 row_shr:8 row_mask:0xf bank_mask:0xf bound_ctrl:0
  v_add_f32_dpp v33, v33, v33 row_shr:8 row_mask:0xf bank_mask:0xf bound_ctrl:0
  v_add_f32_dpp v34, v34, v34 row_shr:8 row_mask:0xf bank_mask:0xf bound_ctrl:0
  v_add_f32_dpp v35, v35, v35 row_shr:8 row_mask:0xf bank_mask:0xf bound_ctrl:0
  v_add_f32_dpp v28, v28, v28 row_bcast:15 row_mask:0xa bank_mask:0xf
  v_add_f32_dpp v29, v29, v29 row_bcast:15 row_mask:0xa bank_mask:0xf
  v_add_f32_dpp v30, v30, v30 row_bcast:15 row_mask:0xa bank_mask:0xf
  v_add_f32_dpp v31, v31, v31 row_bcast:15 row_mask:0xa bank_mask:0xf
  v_add_f32_dpp v32, v32, v32 row_bcast:15 row_mask:0xa bank_mask:0xf
  v_add_f32_dpp v33, v33, v33 row_bcast:15 row_mask:0xa bank_mask:0xf
  v_add_f32_dpp v34, v34, v34 row_bcast:15 row_mask:0xa bank_mask:0xf
  v_add_f32_dpp v35, v35, v35 row_bcast:15 row_mask:0xa bank_mask:0xf
  v_add_f32_dpp v28, v28, v28 row_bcast:31 row_mask:0xc bank_mask:0xf
  v_add_f32_dpp v29, v29, v29 row_bcast:31 row_mask:0xc bank_mask:0xf
  v_add_f32_dpp v30, v30, v30 row_bcast:31 row_mask:0xc bank_mask:0xf
  v_add_f32_dpp v31, v31, v31 row_bcast:31 row_mask:0xc bank_mask:0xf
  v_add_f32_dpp v32, v32, v32 row_bcast:31 row_mask:0xc bank_mask:0xf
  v_add_f32_dpp v33, v33, v33 row_bcast:31 row_mask:0xc bank_mask:0xf
  v_add_f32_dpp v34, v34, v34 row_bcast:31 row_mask:0xc bank_mask:0xf
  v_add_f32_dpp v35, v35, v35 row_bcast:31 row_mask:0xc bank_mask:0xf
  s_lshl_b32 s9, s8, 5
  v_mov_b32 v37, s9
  s_mov_b32 exec_lo, 0
  s_mov_b32 exec_hi, 0x80000000
  ds_write_b128 v37, v[28:31] offset:256
  ds_write_b128 v37, v[32:35] offset:272
  s_mov_b64 exec, -1
  s_waitcnt lgkmcnt(0)
  s_barrier
  v_and_b32 v37, 7, v1
  v_lshlrev_b32 v37, 2, v37
  ds_read_b32 v28, v37 offset:256
  ds_read_b32 v29, v37 offset:288
  ds_read_b32 v30, v37 offset:320
  ds_read_b32 v31, v37 offset:352
  ds_read_b32 v32, v37 offset:384
  s_waitcnt lgkmcnt(0)
  v_add_f32 v40, v28, v29
  v_add_f32 v40, v40, v30
  v_add_f32 v40, v40, v31
  v_add_f32 v40, v40, v32
  v_mul_f32 v40, 0x3acccccd, v40
  v_cvt_pk_bf16_f32 v36, v36, v36
  v_lshlrev_b32 v36, 16, v36
  v_cvt_pk_bf16_f32 v40, v40, v40
  v_lshlrev_b32 v40, 16, v40
  v_add_f32 v40, 0x3727c5ac, v40
  v_cvt_pk_bf16_f32 v40, v40, v40
  v_lshlrev_b32 v40, 16, v40
  v_sqrt_f32 v40, v40
  s_nop 0
  v_cvt_pk_bf16_f32 v40, v40, v40
  v_lshlrev_b32 v40, 16, v40
  v_rcp_f32 v41, v40
  v_readlane_b32 s24, v36, 0
  v_readlane_b32 s25, v36, 1
  v_readlane_b32 s26, v36, 2
  v_readlane_b32 s27, v36, 3
  v_readlane_b32 s28, v36, 4
  v_readlane_b32 s29, v36, 5
  v_readlane_b32 s30, v36, 6
  v_readlane_b32 s31, v36, 7
  v_readlane_b32 s32, v40, 0
  v_readlane_b32 s33, v40, 1
  v_readlane_b32 s34, v40, 2
  v_readlane_b32 s35, v40, 3
  v_readlane_b32 s36, v40, 4
  v_readlane_b32 s37, v40, 5
  v_readlane_b32 s38, v40, 6
  v_readlane_b32 s39, v40, 7
  v_readlane_b32 s40, v41, 0
  v_readlane_b32 s41, v41, 1
  v_readlane_b32 s42, v41, 2
  v_readlane_b32 s43, v41, 3
  v_readlane_b32 s44, v41, 4
  v_readlane_b32 s45, v41, 5
  v_readlane_b32 s46, v41, 6
  v_readlane_b32 s47, v41, 7
  v_subrev_f32 v12, s24, v12
  v_subrev_f32 v13, s24, v13
  v_cvt_pk_bf16_f32 v36, v12, v13
  v_lshlrev_b32 v12, 16, v36
  v_and_b32 v13, 0xffff0000, v36
  v_mul_f32 v37, s40, v12
  v_mul_f32 v38, s40, v13
  v_fma_f32 v39, -v37, s32, v12
  v_fma_f32 v40, -v38, s32, v13
  v_fmac_f32 v37, s40, v39
  v_fmac_f32 v38, s40, v40
  v_cvt_pk_bf16_f32 v36, v37, v38
  v_lshlrev_b32 v12, 16, v36
  v_and_b32 v13, 0xffff0000, v36
  v_subrev_f32 v14, s25, v14
  v_subrev_f32 v15, s25, v15
  v_cvt_pk_bf16_f32 v36, v14, v15
  v_lshlrev_b32 v14, 16, v36
  v_and_b32 v15, 0xffff0000, v36
  v_mul_f32 v37, s41, v14
  v_mul_f32 v38, s41, v15
  v_fma_f32 v39, -v37, s33, v14
  v_fma_f32 v40, -v38, s33, v15
  v_fmac_f32 v37, s41, v39
  v_fmac_f32 v38, s41, v40
  v_cvt_pk_bf16_f32 v36, v37, v38
  v_lshlrev_b32 v14, 16, v36
  v_and_b32 v15, 0xffff0000, v36
  v_subrev_f32 v16, s26, v16
  v_subrev_f32 v17, s26, v17
  v_cvt_pk_bf16_f32 v36, v16, v17
  v_lshlrev_b32 v16, 16, v36
  v_and_b32 v17, 0xffff0000, v36
  v_mul_f32 v37, s42, v16
  v_mul_f32 v38, s42, v17
  v_fma_f32 v39, -v37, s34, v16
  v_fma_f32 v40, -v38, s34, v17
  v_fmac_f32 v37, s42, v39
  v_fmac_f32 v38, s42, v40
  v_cvt_pk_bf16_f32 v36, v37, v38
  v_lshlrev_b32 v16, 16, v36
  v_and_b32 v17, 0xffff0000, v36
  v_subrev_f32 v18, s27, v18
  v_subrev_f32 v19, s27, v19
  v_cvt_pk_bf16_f32 v36, v18, v19
  v_lshlrev_b32 v18, 16, v36
  v_and_b32 v19, 0xffff0000, v36
  v_mul_f32 v37, s43, v18
  v_mul_f32 v38, s43, v19
  v_fma_f32 v39, -v37, s35, v18
  v_fma_f32 v40, -v38, s35, v19
  v_fmac_f32 v37, s43, v39
  v_fmac_f32 v38, s43, v40
  v_cvt_pk_bf16_f32 v36, v37, v38
  v_lshlrev_b32 v18, 16, v36
  v_and_b32 v19, 0xffff0000, v36
  v_subrev_f32 v20, s28, v20
  v_subrev_f32 v21, s28, v21
  v_cvt_pk_bf16_f32 v36, v20, v21
  v_lshlrev_b32 v20, 16, v36
  v_and_b32 v21, 0xffff0000, v36
  v_mul_f32 v37, s44, v20
  v_mul_f32 v38, s44, v21
  v_fma_f32 v39, -v37, s36, v20
  v_fma_f32 v40, -v38, s36, v21
  v_fmac_f32 v37, s44, v39
  v_fmac_f32 v38, s44, v40
  v_cvt_pk_bf16_f32 v36, v37, v38
  v_lshlrev_b32 v20, 16, v36
  v_and_b32 v21, 0xffff0000, v36
  v_subrev_f32 v22, s29, v22
  v_subrev_f32 v23, s29, v23
  v_cvt_pk_bf16_f32 v36, v22, v23
  v_lshlrev_b32 v22, 16, v36
  v_and_b32 v23, 0xffff0000, v36
  v_mul_f32 v37, s45, v22
  v_mul_f32 v38, s45, v23
  v_fma_f32 v39, -v37, s37, v22
  v_fma_f32 v40, -v38, s37, v23
  v_fmac_f32 v37, s45, v39
  v_fmac_f32 v38, s45, v40
  v_cvt_pk_bf16_f32 v36, v37, v38
  v_lshlrev_b32 v22, 16, v36
  v_and_b32 v23, 0xffff0000, v36
  v_subrev_f32 v24, s30, v24
  v_subrev_f32 v25, s30, v25
  v_cvt_pk_bf16_f32 v36, v24, v25
  v_lshlrev_b32 v24, 16, v36
  v_and_b32 v25, 0xffff0000, v36
  v_mul_f32 v37, s46, v24
  v_mul_f32 v38, s46, v25
  v_fma_f32 v39, -v37, s38, v24
  v_fma_f32 v40, -v38, s38, v25
  v_fmac_f32 v37, s46, v39
  v_fmac_f32 v38, s46, v40
  v_cvt_pk_bf16_f32 v36, v37, v38
  v_lshlrev_b32 v24, 16, v36
  v_and_b32 v25, 0xffff0000, v36
  v_subrev_f32 v26, s31, v26
  v_subrev_f32 v27, s31, v27
  v_cvt_pk_bf16_f32 v36, v26, v27
  v_lshlrev_b32 v26, 16, v36
  v_and_b32 v27, 0xffff0000, v36
  v_mul_f32 v37, s47, v26
  v_mul_f32 v38, s47, v27
  v_fma_f32 v39, -v37, s39, v26
  v_fma_f32 v40, -v38, s39, v27
  v_fmac_f32 v37, s47, v39
  v_fmac_f32 v38, s47, v40
  v_cvt_pk_bf16_f32 v36, v37, v38
  v_lshlrev_b32 v26, 16, v36
  v_and_b32 v27, 0xffff0000, v36
  v_cvt_pk_f16_f32 v44, v12, v14
  v_cvt_pk_f16_f32 v45, v16, v18
  v_cvt_pk_f16_f32 v46, v20, v22
  v_cvt_pk_f16_f32 v47, v24, v26
  v_cvt_pk_f16_f32 v48, v13, v15
  v_cvt_pk_f16_f32 v49, v17, v19
  v_cvt_pk_f16_f32 v50, v21, v23
  v_cvt_pk_f16_f32 v51, v25, v27
  s_mul_i32 s3, s2, 10240
  v_lshlrev_b32 v2, 5, v0
  v_add_u32 v2, s3, v2
  global_store_dwordx4 v2, v[44:47], s[6:7] sc1
  global_store_dwordx4 v2, v[48:51], s[6:7] offset:16 sc1
  v_mov_b32 v52, 0
  global_load_dword v53, v52, s[60:61] sc1
  s_waitcnt vmcnt(0)
  s_barrier
  s_add_u32 s14, s6, 0x00540800
  s_addc_u32 s15, s7, 0
  s_add_u32 s10, s6, 0x00540000
  s_addc_u32 s11, s7, 0
  s_add_u32 s12, s6, 0x00600000
  s_addc_u32 s13, s7, 0
  s_cmp_lg_u32 s8, 0
  s_cbranch_scc1 KA_LNS
  s_mov_b32 s27, 0
KA_LNEP:
  v_readfirstlane_b32 s9, v53
  s_nop 0
  s_cmp_lg_u32 s9, 0
  s_cbranch_scc1 KA_LNGO
  s_add_u32 s27, s27, 1
  s_cmp_ge_u32 s27, 0x10000
  s_cbranch_scc1 KA_LNGO
  s_sleep 8
  global_load_dword v53, v52, s[60:61] sc1
  s_waitcnt vmcnt(0)
  s_branch KA_LNEP
KA_LNGO:
  v_mov_b32 v8, 0
  s_lshl_b32 s3, s2, 2
  v_mov_b32 v10, s3
  s_mov_b64 exec, 1
  global_store_dword v10, v53, s[14:15] sc1
  global_store_dword v10, v8, s[10:11]
  s_mov_b64 exec, -1
KA_LNS:
  s_mul_i32 s3, s2, 1920
  v_lshlrev_b32 v2, 3, v0
  v_add_u32 v2, s3, v2
  v_mov_b32 v4, -1
  v_mov_b32 v5, -1
  v_cmp_gt_u32 vcc, 240, v0
  s_nop 0
  s_and_saveexec_b64 s[30:31], vcc
  s_cbranch_execz KA_LNE
  global_store_dwordx2 v2, v[4:5], s[12:13]
KA_LNE:
  s_endpgm
KA_KGEN:
  s_sub_u32 s9, s2, 256
  s_and_b32 s3, s9, 7
  s_mul_i32 s3, s3, 80
  s_lshr_b32 s9, s9, 3
  s_add_u32 s3, s3, s9
  s_load_dwordx4 s[12:15], s[0:1], 8
  s_load_dwordx4 s[16:19], s[0:1], 24
  s_load_dwordx4 s[20:23], s[0:1], 40
  s_load_dwordx4 s[56:59], s[0:1], 56
  s_load_dwordx4 s[48:51], s[0:1], 88
  s_load_dwordx2 s[52:53], s[0:1], 104
  v_lshrrev_b32 v63, 6, v0
  s_nop 0
  v_readfirstlane_b32 s8, v63
  v_and_b32 v1, 63, v0
  s_mul_i32 s26, s8, 9216
  s_mul_i32 s9, s3, 384
  v_lshlrev_b32 v2, 1, v0
  v_add_u32 v2, s9, v2
  s_lshl_b32 s9, s3, 1
  v_mov_b32 v3, s9
  s_waitcnt lgkmcnt(0)
  s_and_b32 s9, s9, -4
  s_load_dword s62, s[58:59], s9
  s_cmp_ge_u32 s8, 3
  s_cbranch_scc1 KA_W34
  global_load_ushort v4, v2, s[12:13]
  global_load_ushort v5, v2, s[14:15]
  global_load_ushort v6, v2, s[16:17]
  global_load_ushort v7, v2, s[18:19]
  global_load_ushort v8, v2, s[20:21]
  global_load_ushort v9, v2, s[22:23]
  global_load_ushort v10, v3, s[56:57]
  s_mov_b32 s27, 0x3fb8aa3b
  s_mov_b32 s28, 0x32a57060
  s_mov_b32 s29, 0x3f317218
  s_waitcnt vmcnt(0)
  v_lshlrev_b32 v4, 16, v4
  v_lshlrev_b32 v5, 16, v5
  v_lshlrev_b32 v6, 16, v6
  v_lshlrev_b32 v7, 16, v7
  v_lshlrev_b32 v8, 16, v8
  v_lshlrev_b32 v9, 16, v9
  v_lshlrev_b32 v10, 16, v10
  v_mul_f32 v11, s27, v10
  v_fma_f32 v12, v10, s27, -v11
  v_fma_f32 v12, v10, s28, v12
  v_exp_f32 v11, v11
  v_mul_f32 v12, s29, v12
  v_fma_f32 v10, v11, v12, v11
  v_cvt_pk_bf16_f32 v10, v10, v10
  v_lshlrev_b32 v10, 16, v10
  v_mul_f32 v4, v10, v4
  v_mul_f32 v5, v10, v5
  v_mul_f32 v6, v10, v6
  v_mul_f32 v7, v10, v7
  v_mul_f32 v14, v9, v7
  v_mul_f32 v15, v9, v6
  v_fma_f32 v12, v8, v6, -v14
  v_fma_f32 v13, v8, v7, v15
  v_sub_f32 v13, 0, v13
  v_mul_f32 v4, s27, v4
  v_mul_f32 v5, 0.15915494, v5
  v_mul_f32 v32, 0x41000000, v4
  v_mul_f32 v36, 0x3f800000, v4
  v_mul_f32 v40, 0x43000000, v4
  v_mul_f32 v33, 0x41000000, v5
  v_mul_f32 v37, 0xbf800000, v5
  v_mul_f32 v41, 0xc3000000, v5
  v_exp_f32 v32, v32
  v_exp_f32 v36, v36
  v_exp_f32 v40, v40
  v_fract_f32 v33, v33
  v_fract_f32 v37, v37
  v_fract_f32 v41, v41
  v_cos_f32 v34, v33
  v_cos_f32 v38, v37
  v_cos_f32 v42, v41
  v_sin_f32 v35, v33
  v_sin_f32 v39, v37
  v_sin_f32 v43, v41
  v_mul_f32 v20, v32, v34
  v_mul_f32 v18, v36, v38
  v_mul_f32 v22, v40, v42
  v_mul_f32 v21, v32, v35
  v_mul_f32 v19, v36, v39
  v_mul_f32 v23, v40, v43
  v_lshlrev_b32 v2, 2, v1
  v_add_u32 v2, s26, v2
  v_and_b32 v6, 15, v1
  v_lshrrev_b32 v7, 4, v1
  v_mul_u32_u24 v3, 576, v6
  v_lshl_add_u32 v3, v7, 4, v3
  v_add_u32 v3, s26, v3
  v_mov_b32 v26, 1.0
  v_mov_b32 v27, 0
  v_pk_mul_f32 v[14:15], v[20:21], v[20:21] op_sel:[0,0] op_sel_hi:[0,1]
  v_cvt_pk_bf16_f32 v8, v26, v27
  v_cvt_pk_bf16_f32 v76, v20, v21
  v_pk_fma_f32 v[24:25], v[20:21], v[20:21], v[14:15] op_sel:[1,1,0] op_sel_hi:[1,0,1] neg_lo:[1,0,0]
  v_lshlrev_b32 v10, 16, v8
  v_lshlrev_b32 v78, 16, v76
  v_and_b32 v11, 0xffff0000, v8
  v_and_b32 v79, 0xffff0000, v76
  ds_write_b32 v2, v8 offset:0
  ds_write_b32 v2, v76 offset:576
  v_pk_add_f32 v[10:11], v[26:27], v[10:11] neg_lo:[0,1] neg_hi:[0,1]
  v_pk_add_f32 v[78:79], v[20:21], v[78:79] neg_lo:[0,1] neg_hi:[0,1]
  v_cvt_pk_bf16_f32 v9, v10, v11
  v_cvt_pk_bf16_f32 v77, v78, v79
  ds_write_b32 v2, v9 offset:288
  ds_write_b32 v2, v77 offset:864
  v_pk_mul_f32 v[16:17], v[20:21], v[24:25] op_sel:[0,0] op_sel_hi:[0,1]
  v_pk_fma_f32 v[28:29], v[20:21], v[24:25], v[16:17] op_sel:[1,1,0] op_sel_hi:[1,0,1] neg_lo:[1,0,0]
  v_cvt_pk_bf16_f32 v8, v24, v25
  v_cvt_pk_bf16_f32 v76, v28, v29
  v_lshlrev_b32 v10, 16, v8
  v_lshlrev_b32 v78, 16, v76
  v_and_b32 v11, 0xffff0000, v8
  v_and_b32 v79, 0xffff0000, v76
  ds_write_b32 v2, v8 offset:1152
  ds_write_b32 v2, v76 offset:1728
  v_pk_add_f32 v[10:11], v[24:25], v[10:11] neg_lo:[0,1] neg_hi:[0,1]
  v_pk_add_f32 v[78:79], v[28:29], v[78:79] neg_lo:[0,1] neg_hi:[0,1]
  v_cvt_pk_bf16_f32 v9, v10, v11
  v_cvt_pk_bf16_f32 v77, v78, v79
  ds_write_b32 v2, v9 offset:1440
  ds_write_b32 v2, v77 offset:2016
  v_pk_mul_f32 v[14:15], v[24:25], v[24:25] op_sel:[0,0] op_sel_hi:[0,1]
  v_pk_mul_f32 v[16:17], v[28:29], v[24:25] op_sel:[0,0] op_sel_hi:[0,1]
  v_pk_fma_f32 v[26:27], v[24:25], v[24:25], v[14:15] op_sel:[1,1,0] op_sel_hi:[1,0,1] neg_lo:[1,0,0]
  v_pk_fma_f32 v[62:63], v[28:29], v[24:25], v[16:17] op_sel:[1,1,0] op_sel_hi:[1,0,1] neg_lo:[1,0,0]
  v_cvt_pk_bf16_f32 v8, v26, v27
  v_cvt_pk_bf16_f32 v76, v62, v63
  v_lshlrev_b32 v10, 16, v8
  v_lshlrev_b32 v78, 16, v76
  v_and_b32 v11, 0xffff0000, v8
  v_and_b32 v79, 0xffff0000, v76
  ds_write_b32 v2, v8 offset:2304
  ds_write_b32 v2, v76 offset:2880
  v_pk_add_f32 v[10:11], v[26:27], v[10:11] neg_lo:[0,1] neg_hi:[0,1]
  v_pk_add_f32 v[78:79], v[62:63], v[78:79] neg_lo:[0,1] neg_hi:[0,1]
  v_cvt_pk_bf16_f32 v9, v10, v11
  v_cvt_pk_bf16_f32 v77, v78, v79
  ds_write_b32 v2, v9 offset:2592
  ds_write_b32 v2, v77 offset:3168
  v_pk_mul_f32 v[14:15], v[26:27], v[24:25] op_sel:[0,0] op_sel_hi:[0,1]
  v_pk_mul_f32 v[16:17], v[62:63], v[24:25] op_sel:[0,0] op_sel_hi:[0,1]
  v_pk_fma_f32 v[30:31], v[26:27], v[24:25], v[14:15] op_sel:[1,1,0] op_sel_hi:[1,0,1] neg_lo:[1,0,0]
  v_pk_fma_f32 v[28:29], v[62:63], v[24:25], v[16:17] op_sel:[1,1,0] op_sel_hi:[1,0,1] neg_lo:[1,0,0]
  v_cvt_pk_bf16_f32 v8, v30, v31
  v_cvt_pk_bf16_f32 v76, v28, v29
  v_lshlrev_b32 v10, 16, v8
  v_lshlrev_b32 v78, 16, v76
  v_and_b32 v11, 0xffff0000, v8
  v_and_b32 v79, 0xffff0000, v76
  ds_write_b32 v2, v8 offset:3456
  ds_write_b32 v2, v76 offset:4032
  v_pk_add_f32 v[10:11], v[30:31], v[10:11] neg_lo:[0,1] neg_hi:[0,1]
  v_pk_add_f32 v[78:79], v[28:29], v[78:79] neg_lo:[0,1] neg_hi:[0,1]
  v_cvt_pk_bf16_f32 v9, v10, v11
  v_cvt_pk_bf16_f32 v77, v78, v79
  ds_write_b32 v2, v9 offset:3744
  ds_write_b32 v2, v77 offset:4320
  v_pk_mul_f32 v[14:15], v[30:31], v[24:25] op_sel:[0,0] op_sel_hi:[0,1]
  v_pk_mul_f32 v[16:17], v[28:29], v[24:25] op_sel:[0,0] op_sel_hi:[0,1]
  v_pk_fma_f32 v[26:27], v[30:31], v[24:25], v[14:15] op_sel:[1,1,0] op_sel_hi:[1,0,1] neg_lo:[1,0,0]
  v_pk_fma_f32 v[62:63], v[28:29], v[24:25], v[16:17] op_sel:[1,1,0] op_sel_hi:[1,0,1] neg_lo:[1,0,0]
  v_cvt_pk_bf16_f32 v8, v26, v27
  v_cvt_pk_bf16_f32 v76, v62, v63
  v_lshlrev_b32 v10, 16, v8
  v_lshlrev_b32 v78, 16, v76
  v_and_b32 v11, 0xffff0000, v8
  v_and_b32 v79, 0xffff0000, v76
  ds_write_b32 v2, v8 offset:4608
  ds_write_b32 v2, v76 offset:5184
  v_pk_add_f32 v[10:11], v[26:27], v[10:11] neg_lo:[0,1] neg_hi:[0,1]
  v_pk_add_f32 v[78:79], v[62:63], v[78:79] neg_lo:[0,1] neg_hi:[0,1]
  v_cvt_pk_bf16_f32 v9, v10, v11
  v_cvt_pk_bf16_f32 v77, v78, v79
  ds_write_b32 v2, v9 offset:4896
  ds_write_b32 v2, v77 offset:5472
  v_pk_mul_f32 v[14:15], v[26:27], v[24:25] op_sel:[0,0] op_sel_hi:[0,1]
  v_pk_mul_f32 v[16:17], v[62:63], v[24:25] op_sel:[0,0] op_sel_hi:[0,1]
  v_pk_fma_f32 v[30:31], v[26:27], v[24:25], v[14:15] op_sel:[1,1,0] op_sel_hi:[1,0,1] neg_lo:[1,0,0]
  v_pk_fma_f32 v[28:29], v[62:63], v[24:25], v[16:17] op_sel:[1,1,0] op_sel_hi:[1,0,1] neg_lo:[1,0,0]
  v_cvt_pk_bf16_f32 v8, v30, v31
  v_cvt_pk_bf16_f32 v76, v28, v29
  v_lshlrev_b32 v10, 16, v8
  v_lshlrev_b32 v78, 16, v76
  v_and_b32 v11, 0xffff0000, v8
  v_and_b32 v79, 0xffff0000, v76
  ds_write_b32 v2, v8 offset:5760
  ds_write_b32 v2, v76 offset:6336
  v_pk_add_f32 v[10:11], v[30:31], v[10:11] neg_lo:[0,1] neg_hi:[0,1]
  v_pk_add_f32 v[78:79], v[28:29], v[78:79] neg_lo:[0,1] neg_hi:[0,1]
  v_cvt_pk_bf16_f32 v9, v10, v11
  v_cvt_pk_bf16_f32 v77, v78, v79
  ds_write_b32 v2, v9 offset:6048
  ds_write_b32 v2, v77 offset:6624
  v_pk_mul_f32 v[14:15], v[30:31], v[24:25] op_sel:[0,0] op_sel_hi:[0,1]
  v_pk_mul_f32 v[16:17], v[28:29], v[24:25] op_sel:[0,0] op_sel_hi:[0,1]
  v_pk_fma_f32 v[26:27], v[30:31], v[24:25], v[14:15] op_sel:[1,1,0] op_sel_hi:[1,0,1] neg_lo:[1,0,0]
  v_pk_fma_f32 v[62:63], v[28:29], v[24:25], v[16:17] op_sel:[1,1,0] op_sel_hi:[1,0,1] neg_lo:[1,0,0]
  v_cvt_pk_bf16_f32 v8, v26, v27
  v_cvt_pk_bf16_f32 v76, v62, v63
  v_lshlrev_b32 v10, 16, v8
  v_lshlrev_b32 v78, 16, v76
  v_and_b32 v11, 0xffff0000, v8
  v_and_b32 v79, 0xffff0000, v76
  ds_write_b32 v2, v8 offset:6912
  ds_write_b32 v2, v76 offset:7488
  v_pk_add_f32 v[10:11], v[26:27], v[10:11] neg_lo:[0,1] neg_hi:[0,1]
  v_pk_add_f32 v[78:79], v[62:63], v[78:79] neg_lo:[0,1] neg_hi:[0,1]
  v_cvt_pk_bf16_f32 v9, v10, v11
  v_cvt_pk_bf16_f32 v77, v78, v79
  ds_write_b32 v2, v9 offset:7200
  ds_write_b32 v2, v77 offset:7776
  v_pk_mul_f32 v[14:15], v[26:27], v[24:25] op_sel:[0,0] op_sel_hi:[0,1]
  v_pk_mul_f32 v[16:17], v[62:63], v[24:25] op_sel:[0,0] op_sel_hi:[0,1]
  v_pk_fma_f32 v[30:31], v[26:27], v[24:25], v[14:15] op_sel:[1,1,0] op_sel_hi:[1,0,1] neg_lo:[1,0,0]
  v_pk_fma_f32 v[28:29], v[62:63], v[24:25], v[16:17] op_sel:[1,1,0] op_sel_hi:[1,0,1] neg_lo:[1,0,0]
  v_cvt_pk_bf16_f32 v8, v30, v31
  v_cvt_pk_bf16_f32 v76, v28, v29
  v_lshlrev_b32 v10, 16, v8
  v_lshlrev_b32 v78, 16, v76
  v_and_b32 v11, 0xffff0000, v8
  v_and_b32 v79, 0xffff0000, v76
  ds_write_b32 v2, v8 offset:8064
  ds_write_b32 v2, v76 offset:8640
  v_pk_add_f32 v[10:11], v[30:31], v[10:11] neg_lo:[0,1] neg_hi:[0,1]
  v_pk_add_f32 v[78:79], v[28:29], v[78:79] neg_lo:[0,1] neg_hi:[0,1]
  v_cvt_pk_bf16_f32 v9, v10, v11
  v_cvt_pk_bf16_f32 v77, v78, v79
  ds_write_b32 v2, v9 offset:8352
  ds_write_b32 v2, v77 offset:8928
  s_waitcnt lgkmcnt(0)
  ds_read_b128 v[32:35], v3 offset:0
  ds_read_b128 v[48:51], v3 offset:288
  ds_read_b128 v[36:39], v3 offset:64
  ds_read_b128 v[52:55], v3 offset:352
  ds_read_b128 v[40:43], v3 offset:128
  ds_read_b128 v[56:59], v3 offset:416
  ds_read_b128 v[44:47], v3 offset:192
  ds_read_b128 v[60:63], v3 offset:480
  s_waitcnt lgkmcnt(0)
  v_pk_mul_f32 v[16:17], v[12:13], v[22:23] op_sel:[0,0] op_sel_hi:[0,1]
  v_pk_mul_f32 v[14:15], v[12:13], v[18:19] op_sel:[0,0] op_sel_hi:[0,1]
  v_cvt_pk_bf16_f32 v8, v12, v13
  v_pk_fma_f32 v[30:31], v[12:13], v[22:23], v[16:17] op_sel:[1,1,0] op_sel_hi:[1,0,1] neg_lo:[1,0,0]
  v_pk_fma_f32 v[26:27], v[12:13], v[18:19], v[14:15] op_sel:[1,1,0] op_sel_hi:[1,0,1] neg_lo:[1,0,0]
  v_lshlrev_b32 v10, 16, v8
  v_and_b32 v11, 0xffff0000, v8
  ds_write_b32 v2, v8 offset:0
  v_pk_add_f32 v[10:11], v[12:13], v[10:11] neg_lo:[0,1] neg_hi:[0,1]
  v_cvt_pk_bf16_f32 v9, v10, v11
  ds_write_b32 v2, v9 offset:288
  v_cvt_pk_bf16_f32 v76, v30, v31
  v_lshlrev_b32 v78, 16, v76
  v_and_b32 v79, 0xffff0000, v76
  ds_write_b32 v2, v76 offset:4608
  v_pk_add_f32 v[78:79], v[30:31], v[78:79] neg_lo:[0,1] neg_hi:[0,1]
  v_cvt_pk_bf16_f32 v77, v78, v79
  ds_write_b32 v2, v77 offset:4896
  v_pk_mul_f32 v[16:17], v[26:27], v[22:23] op_sel:[0,0] op_sel_hi:[0,1]
  v_pk_mul_f32 v[14:15], v[26:27], v[18:19] op_sel:[0,0] op_sel_hi:[0,1]
  v_cvt_pk_bf16_f32 v8, v26, v27
  v_pk_fma_f32 v[30:31], v[26:27], v[22:23], v[16:17] op_sel:[1,1,0] op_sel_hi:[1,0,1] neg_lo:[1,0,0]
  v_pk_fma_f32 v[28:29], v[26:27], v[18:19], v[14:15] op_sel:[1,1,0] op_sel_hi:[1,0,1] neg_lo:[1,0,0]
  v_lshlrev_b32 v10, 16, v8
  v_and_b32 v11, 0xffff0000, v8
  ds_write_b32 v2, v8 offset:576
  v_pk_add_f32 v[10:11], v[26:27], v[10:11] neg_lo:[0,1] neg_hi:[0,1]
  v_cvt_pk_bf16_f32 v9, v10, v11
  ds_write_b32 v2, v9 offset:864
  v_cvt_pk_bf16_f32 v76, v30, v31
  v_lshlrev_b32 v78, 16, v76
  v_and_b32 v79, 0xffff0000, v76
  ds_write_b32 v2, v76 offset:5184
  v_pk_add_f32 v[78:79], v[30:31], v[78:79] neg_lo:[0,1] neg_hi:[0,1]
  v_cvt_pk_bf16_f32 v77, v78, v79
  ds_write_b32 v2, v77 offset:5472
  v_pk_mul_f32 v[16:17], v[28:29], v[22:23] op_sel:[0,0] op_sel_hi:[0,1]
  v_pk_mul_f32 v[14:15], v[28:29], v[18:19] op_sel:[0,0] op_sel_hi:[0,1]
  v_cvt_pk_bf16_f32 v8, v28, v29
  v_pk_fma_f32 v[30:31], v[28:29], v[22:23], v[16:17] op_sel:[1,1,0] op_sel_hi:[1,0,1] neg_lo:[1,0,0]
  v_pk_fma_f32 v[26:27], v[28:29], v[18:19], v[14:15] op_sel:[1,1,0] op_sel_hi:[1,0,1] neg_lo:[1,0,0]
  v_lshlrev_b32 v10, 16, v8
  v_and_b32 v11, 0xffff0000, v8
  ds_write_b32 v2, v8 offset:1152
  v_pk_add_f32 v[10:11], v[28:29], v[10:11] neg_lo:[0,1] neg_hi:[0,1]
  v_cvt_pk_bf16_f32 v9, v10, v11
  ds_write_b32 v2, v9 offset:1440
  v_cvt_pk_bf16_f32 v76, v30, v31
  v_lshlrev_b32 v78, 16, v76
  v_and_b32 v79, 0xffff0000, v76
  ds_write_b32 v2, v76 offset:5760
  v_pk_add_f32 v[78:79], v[30:31], v[78:79] neg_lo:[0,1] neg_hi:[0,1]
  v_cvt_pk_bf16_f32 v77, v78, v79
  ds_write_b32 v2, v77 offset:6048
  v_pk_mul_f32 v[16:17], v[26:27], v[22:23] op_sel:[0,0] op_sel_hi:[0,1]
  v_pk_mul_f32 v[14:15], v[26:27], v[18:19] op_sel:[0,0] op_sel_hi:[0,1]
  v_cvt_pk_bf16_f32 v8, v26, v27
  v_pk_fma_f32 v[30:31], v[26:27], v[22:23], v[16:17] op_sel:[1,1,0] op_sel_hi:[1,0,1] neg_lo:[1,0,0]
  v_pk_fma_f32 v[28:29], v[26:27], v[18:19], v[14:15] op_sel:[1,1,0] op_sel_hi:[1,0,1] neg_lo:[1,0,0]
  v_lshlrev_b32 v10, 16, v8
  v_and_b32 v11, 0xffff0000, v8
  ds_write_b32 v2, v8 offset:1728
  v_pk_add_f32 v[10:11], v[26:27], v[10:11] neg_lo:[0,1] neg_hi:[0,1]
  v_cvt_pk_bf16_f32 v9, v10, v11
  ds_write_b32 v2, v9 offset:2016
  v_cvt_pk_bf16_f32 v76, v30, v31
  v_lshlrev_b32 v78, 16, v76
  v_and_b32 v79, 0xffff0000, v76
  ds_write_b32 v2, v76 offset:6336
  v_pk_add_f32 v[78:79], v[30:31], v[78:79] neg_lo:[0,1] neg_hi:[0,1]
  v_cvt_pk_bf16_f32 v77, v78, v79
  ds_write_b32 v2, v77 offset:6624
  v_pk_mul_f32 v[16:17], v[28:29], v[22:23] op_sel:[0,0] op_sel_hi:[0,1]
  v_pk_mul_f32 v[14:15], v[28:29], v[18:19] op_sel:[0,0] op_sel_hi:[0,1]
  v_cvt_pk_bf16_f32 v8, v28, v29
  v_pk_fma_f32 v[30:31], v[28:29], v[22:23], v[16:17] op_sel:[1,1,0] op_sel_hi:[1,0,1] neg_lo:[1,0,0]
  v_pk_fma_f32 v[26:27], v[28:29], v[18:19], v[14:15] op_sel:[1,1,0] op_sel_hi:[1,0,1] neg_lo:[1,0,0]
  v_lshlrev_b32 v10, 16, v8
  v_and_b32 v11, 0xffff0000, v8
  ds_write_b32 v2, v8 offset:2304
  v_pk_add_f32 v[10:11], v[28:29], v[10:11] neg_lo:[0,1] neg_hi:[0,1]
  v_cvt_pk_bf16_f32 v9, v10, v11
  ds_write_b32 v2, v9 offset:2592
  v_cvt_pk_bf16_f32 v76, v30, v31
  v_lshlrev_b32 v78, 16, v76
  v_and_b32 v79, 0xffff0000, v76
  ds_write_b32 v2, v76 offset:6912
  v_pk_add_f32 v[78:79], v[30:31], v[78:79] neg_lo:[0,1] neg_hi:[0,1]
  v_cvt_pk_bf16_f32 v77, v78, v79
  ds_write_b32 v2, v77 offset:7200
  v_pk_mul_f32 v[16:17], v[26:27], v[22:23] op_sel:[0,0] op_sel_hi:[0,1]
  v_pk_mul_f32 v[14:15], v[26:27], v[18:19] op_sel:[0,0] op_sel_hi:[0,1]
  v_cvt_pk_bf16_f32 v8, v26, v27
  v_pk_fma_f32 v[30:31], v[26:27], v[22:23], v[16:17] op_sel:[1,1,0] op_sel_hi:[1,0,1] neg_lo:[1,0,0]
  v_pk_fma_f32 v[28:29], v[26:27], v[18:19], v[14:15] op_sel:[1,1,0] op_sel_hi:[1,0,1] neg_lo:[1,0,0]
  v_lshlrev_b32 v10, 16, v8
  v_and_b32 v11, 0xffff0000, v8
  ds_write_b32 v2, v8 offset:2880
  v_pk_add_f32 v[10:11], v[26:27], v[10:11] neg_lo:[0,1] neg_hi:[0,1]
  v_cvt_pk_bf16_f32 v9, v10, v11
  ds_write_b32 v2, v9 offset:3168
  v_cvt_pk_bf16_f32 v76, v30, v31
  v_lshlrev_b32 v78, 16, v76
  v_and_b32 v79, 0xffff0000, v76
  ds_write_b32 v2, v76 offset:7488
  v_pk_add_f32 v[78:79], v[30:31], v[78:79] neg_lo:[0,1] neg_hi:[0,1]
  v_cvt_pk_bf16_f32 v77, v78, v79
  ds_write_b32 v2, v77 offset:7776
  v_pk_mul_f32 v[16:17], v[28:29], v[22:23] op_sel:[0,0] op_sel_hi:[0,1]
  v_pk_mul_f32 v[14:15], v[28:29], v[18:19] op_sel:[0,0] op_sel_hi:[0,1]
  v_cvt_pk_bf16_f32 v8, v28, v29
  v_pk_fma_f32 v[30:31], v[28:29], v[22:23], v[16:17] op_sel:[1,1,0] op_sel_hi:[1,0,1] neg_lo:[1,0,0]
  v_pk_fma_f32 v[26:27], v[28:29], v[18:19], v[14:15] op_sel:[1,1,0] op_sel_hi:[1,0,1] neg_lo:[1,0,0]
  v_lshlrev_b32 v10, 16, v8
  v_and_b32 v11, 0xffff0000, v8
  ds_write_b32 v2, v8 offset:3456
  v_pk_add_f32 v[10:11], v[28:29], v[10:11] neg_lo:[0,1] neg_hi:[0,1]
  v_cvt_pk_bf16_f32 v9, v10, v11
  ds_write_b32 v2, v9 offset:3744
  v_cvt_pk_bf16_f32 v76, v30, v31
  v_lshlrev_b32 v78, 16, v76
  v_and_b32 v79, 0xffff0000, v76
  ds_write_b32 v2, v76 offset:8064
  v_pk_add_f32 v[78:79], v[30:31], v[78:79] neg_lo:[0,1] neg_hi:[0,1]
  v_cvt_pk_bf16_f32 v77, v78, v79
  ds_write_b32 v2, v77 offset:8352
  v_pk_mul_f32 v[16:17], v[26:27], v[22:23] op_sel:[0,0] op_sel_hi:[0,1]
  v_cvt_pk_bf16_f32 v8, v26, v27
  v_pk_fma_f32 v[30:31], v[26:27], v[22:23], v[16:17] op_sel:[1,1,0] op_sel_hi:[1,0,1] neg_lo:[1,0,0]
  v_lshlrev_b32 v10, 16, v8
  v_and_b32 v11, 0xffff0000, v8
  ds_write_b32 v2, v8 offset:4032
  v_pk_add_f32 v[10:11], v[26:27], v[10:11] neg_lo:[0,1] neg_hi:[0,1]
  v_cvt_pk_bf16_f32 v9, v10, v11
  ds_write_b32 v2, v9 offset:4320
  v_cvt_pk_bf16_f32 v76, v30, v31
  v_lshlrev_b32 v78, 16, v76
  v_and_b32 v79, 0xffff0000, v76
  ds_write_b32 v2, v76 offset:8640
  v_pk_add_f32 v[78:79], v[30:31], v[78:79] neg_lo:[0,1] neg_hi:[0,1]
  v_cvt_pk_bf16_f32 v77, v78, v79
  ds_write_b32 v2, v77 offset:8928
  s_waitcnt lgkmcnt(0)
  ds_read_b128 v[8:11], v3 offset:0
  ds_read_b128 v[76:79], v3 offset:288
  ds_read_b128 v[24:27], v3 offset:64
  ds_read_b128 v[28:31], v3 offset:352
  s_waitcnt lgkmcnt(2)
  v_mfma_f32_16x16x32_bf16 v[64:67], v[76:79], v[32:35], 0
  v_mfma_f32_16x16x32_bf16 v[64:67], v[8:11], v[48:51], v[64:67]
  v_mfma_f32_16x16x32_bf16 v[64:67], v[8:11], v[32:35], v[64:67]
  s_waitcnt lgkmcnt(0)
  v_mfma_f32_16x16x32_bf16 v[64:67], v[28:31], v[36:39], v[64:67]
  v_mfma_f32_16x16x32_bf16 v[64:67], v[24:27], v[52:55], v[64:67]
  v_mfma_f32_16x16x32_bf16 v[64:67], v[24:27], v[36:39], v[64:67]
  ds_read_b128 v[8:11], v3 offset:128
  ds_read_b128 v[76:79], v3 offset:416
  ds_read_b128 v[24:27], v3 offset:192
  ds_read_b128 v[28:31], v3 offset:480
  s_waitcnt lgkmcnt(2)
  v_mfma_f32_16x16x32_bf16 v[64:67], v[76:79], v[40:43], v[64:67]
  v_mfma_f32_16x16x32_bf16 v[64:67], v[8:11], v[56:59], v[64:67]
  v_mfma_f32_16x16x32_bf16 v[64:67], v[8:11], v[40:43], v[64:67]
  s_waitcnt lgkmcnt(0)
  v_mfma_f32_16x16x32_bf16 v[64:67], v[28:31], v[44:47], v[64:67]
  v_mfma_f32_16x16x32_bf16 v[64:67], v[24:27], v[60:63], v[64:67]
  v_mfma_f32_16x16x32_bf16 v[64:67], v[24:27], v[44:47], v[64:67]
  v_pk_mul_f32 v[14:15], v[22:23], v[22:23] op_sel:[0,0] op_sel_hi:[0,1]
  v_pk_mul_f32 v[16:17], v[18:19], v[18:19] op_sel:[0,0] op_sel_hi:[0,1]
  v_pk_fma_f32 v[24:25], v[22:23], v[22:23], v[14:15] op_sel:[1,1,0] op_sel_hi:[1,0,1] neg_lo:[1,0,0]
  v_pk_fma_f32 v[18:19], v[18:19], v[18:19], v[16:17] op_sel:[1,1,0] op_sel_hi:[1,0,1] neg_lo:[1,0,0]
  v_pk_mul_f32 v[14:15], v[12:13], v[24:25] op_sel:[0,0] op_sel_hi:[0,1]
  v_pk_fma_f32 v[20:21], v[12:13], v[24:25], v[14:15] op_sel:[1,1,0] op_sel_hi:[1,0,1] neg_lo:[1,0,0]
  v_pk_mul_f32 v[16:17], v[24:25], v[24:25] op_sel:[0,0] op_sel_hi:[0,1]
  v_pk_fma_f32 v[24:25], v[24:25], v[24:25], v[16:17] op_sel:[1,1,0] op_sel_hi:[1,0,1] neg_lo:[1,0,0]
  v_pk_mul_f32 v[16:17], v[20:21], v[22:23] op_sel:[0,0] op_sel_hi:[0,1]
  v_pk_mul_f32 v[14:15], v[20:21], v[18:19] op_sel:[0,0] op_sel_hi:[0,1]
  v_cvt_pk_bf16_f32 v8, v20, v21
  v_pk_fma_f32 v[30:31], v[20:21], v[22:23], v[16:17] op_sel:[1,1,0] op_sel_hi:[1,0,1] neg_lo:[1,0,0]
  v_pk_fma_f32 v[26:27], v[20:21], v[18:19], v[14:15] op_sel:[1,1,0] op_sel_hi:[1,0,1] neg_lo:[1,0,0]
  v_lshlrev_b32 v10, 16, v8
  v_and_b32 v11, 0xffff0000, v8
  ds_write_b32 v2, v8 offset:0
  v_pk_add_f32 v[10:11], v[20:21], v[10:11] neg_lo:[0,1] neg_hi:[0,1]
  v_cvt_pk_bf16_f32 v9, v10, v11
  ds_write_b32 v2, v9 offset:288
  v_cvt_pk_bf16_f32 v76, v30, v31
  v_lshlrev_b32 v78, 16, v76
  v_and_b32 v79, 0xffff0000, v76
  ds_write_b32 v2, v76 offset:2304
  v_pk_add_f32 v[78:79], v[30:31], v[78:79] neg_lo:[0,1] neg_hi:[0,1]
  v_cvt_pk_bf16_f32 v77, v78, v79
  ds_write_b32 v2, v77 offset:2592
  v_pk_mul_f32 v[16:17], v[26:27], v[22:23] op_sel:[0,0] op_sel_hi:[0,1]
  v_pk_mul_f32 v[14:15], v[26:27], v[18:19] op_sel:[0,0] op_sel_hi:[0,1]
  v_cvt_pk_bf16_f32 v8, v26, v27
  v_pk_fma_f32 v[30:31], v[26:27], v[22:23], v[16:17] op_sel:[1,1,0] op_sel_hi:[1,0,1] neg_lo:[1,0,0]
  v_pk_fma_f32 v[28:29], v[26:27], v[18:19], v[14:15] op_sel:[1,1,0] op_sel_hi:[1,0,1] neg_lo:[1,0,0]
  v_lshlrev_b32 v10, 16, v8
  v_and_b32 v11, 0xffff0000, v8
  ds_write_b32 v2, v8 offset:576
  v_pk_add_f32 v[10:11], v[26:27], v[10:11] neg_lo:[0,1] neg_hi:[0,1]
  v_cvt_pk_bf16_f32 v9, v10, v11
  ds_write_b32 v2, v9 offset:864
  v_cvt_pk_bf16_f32 v76, v30, v31
  v_lshlrev_b32 v78, 16, v76
  v_and_b32 v79, 0xffff0000, v76
  ds_write_b32 v2, v76 offset:2880
  v_pk_add_f32 v[78:79], v[30:31], v[78:79] neg_lo:[0,1] neg_hi:[0,1]
  v_cvt_pk_bf16_f32 v77, v78, v79
  ds_write_b32 v2, v77 offset:3168
  v_pk_mul_f32 v[16:17], v[28:29], v[22:23] op_sel:[0,0] op_sel_hi:[0,1]
  v_pk_mul_f32 v[14:15], v[28:29], v[18:19] op_sel:[0,0] op_sel_hi:[0,1]
  v_cvt_pk_bf16_f32 v8, v28, v29
  v_pk_fma_f32 v[30:31], v[28:29], v[22:23], v[16:17] op_sel:[1,1,0] op_sel_hi:[1,0,1] neg_lo:[1,0,0]
  v_pk_fma_f32 v[26:27], v[28:29], v[18:19], v[14:15] op_sel:[1,1,0] op_sel_hi:[1,0,1] neg_lo:[1,0,0]
  v_lshlrev_b32 v10, 16, v8
  v_and_b32 v11, 0xffff0000, v8
  ds_write_b32 v2, v8 offset:1152
  v_pk_add_f32 v[10:11], v[28:29], v[10:11] neg_lo:[0,1] neg_hi:[0,1]
  v_cvt_pk_bf16_f32 v9, v10, v11
  ds_write_b32 v2, v9 offset:1440
  v_cvt_pk_bf16_f32 v76, v30, v31
  v_lshlrev_b32 v78, 16, v76
  v_and_b32 v79, 0xffff0000, v76
  ds_write_b32 v2, v76 offset:3456
  v_pk_add_f32 v[78:79], v[30:31], v[78:79] neg_lo:[0,1] neg_hi:[0,1]
  v_cvt_pk_bf16_f32 v77, v78, v79
  ds_write_b32 v2, v77 offset:3744
  v_pk_mul_f32 v[16:17], v[26:27], v[22:23] op_sel:[0,0] op_sel_hi:[0,1]
  v_cvt_pk_bf16_f32 v8, v26, v27
  v_pk_fma_f32 v[30:31], v[26:27], v[22:23], v[16:17] op_sel:[1,1,0] op_sel_hi:[1,0,1] neg_lo:[1,0,0]
  v_lshlrev_b32 v10, 16, v8
  v_and_b32 v11, 0xffff0000, v8
  ds_write_b32 v2, v8 offset:1728
  v_pk_add_f32 v[10:11], v[26:27], v[10:11] neg_lo:[0,1] neg_hi:[0,1]
  v_cvt_pk_bf16_f32 v9, v10, v11
  ds_write_b32 v2, v9 offset:2016
  v_cvt_pk_bf16_f32 v76, v30, v31
  v_lshlrev_b32 v78, 16, v76
  v_and_b32 v79, 0xffff0000, v76
  ds_write_b32 v2, v76 offset:4032
  v_pk_add_f32 v[78:79], v[30:31], v[78:79] neg_lo:[0,1] neg_hi:[0,1]
  v_cvt_pk_bf16_f32 v77, v78, v79
  ds_write_b32 v2, v77 offset:4320
  v_pk_mul_f32 v[16:17], v[18:19], v[18:19] op_sel:[0,0] op_sel_hi:[0,1]
  v_pk_mul_f32 v[14:15], v[12:13], v[24:25] op_sel:[0,0] op_sel_hi:[0,1]
  v_pk_fma_f32 v[18:19], v[18:19], v[18:19], v[16:17] op_sel:[1,1,0] op_sel_hi:[1,0,1] neg_lo:[1,0,0]
  v_pk_fma_f32 v[26:27], v[12:13], v[24:25], v[14:15] op_sel:[1,1,0] op_sel_hi:[1,0,1] neg_lo:[1,0,0]
  v_pk_mul_f32 v[16:17], v[26:27], v[18:19] op_sel:[0,0] op_sel_hi:[0,1]
  v_pk_fma_f32 v[28:29], v[26:27], v[18:19], v[16:17] op_sel:[1,1,0] op_sel_hi:[1,0,1] neg_lo:[1,0,0]
  v_pk_mul_f32 v[14:15], v[26:27], v[22:23] op_sel:[0,0] op_sel_hi:[0,1]
  v_pk_mul_f32 v[16:17], v[28:29], v[22:23] op_sel:[0,0] op_sel_hi:[0,1]
  v_pk_fma_f32 v[30:31], v[26:27], v[22:23], v[14:15] op_sel:[1,1,0] op_sel_hi:[1,0,1] neg_lo:[1,0,0]
  v_pk_fma_f32 v[20:21], v[28:29], v[22:23], v[16:17] op_sel:[1,1,0] op_sel_hi:[1,0,1] neg_lo:[1,0,0]
  v_cvt_pk_bf16_f32 v8, v26, v27
  v_cvt_pk_bf16_f32 v76, v28, v29
  v_lshlrev_b32 v10, 16, v8
  v_lshlrev_b32 v78, 16, v76
  v_and_b32 v11, 0xffff0000, v8
  v_and_b32 v79, 0xffff0000, v76
  ds_write_b32 v2, v8 offset:4608
  ds_write_b32 v2, v76 offset:5184
  v_pk_add_f32 v[10:11], v[26:27], v[10:11] neg_lo:[0,1] neg_hi:[0,1]
  v_pk_add_f32 v[78:79], v[28:29], v[78:79] neg_lo:[0,1] neg_hi:[0,1]
  v_cvt_pk_bf16_f32 v9, v10, v11
  v_cvt_pk_bf16_f32 v77, v78, v79
  ds_write_b32 v2, v9 offset:4896
  ds_write_b32 v2, v77 offset:5472
  v_pk_mul_f32 v[14:15], v[30:31], v[22:23] op_sel:[0,0] op_sel_hi:[0,1]
  v_pk_mul_f32 v[16:17], v[20:21], v[22:23] op_sel:[0,0] op_sel_hi:[0,1]
  v_pk_fma_f32 v[26:27], v[30:31], v[22:23], v[14:15] op_sel:[1,1,0] op_sel_hi:[1,0,1] neg_lo:[1,0,0]
  v_pk_fma_f32 v[28:29], v[20:21], v[22:23], v[16:17] op_sel:[1,1,0] op_sel_hi:[1,0,1] neg_lo:[1,0,0]
  v_cvt_pk_bf16_f32 v8, v30, v31
  v_cvt_pk_bf16_f32 v76, v20, v21
  v_lshlrev_b32 v10, 16, v8
  v_lshlrev_b32 v78, 16, v76
  v_and_b32 v11, 0xffff0000, v8
  v_and_b32 v79, 0xffff0000, v76
  ds_write_b32 v2, v8 offset:5760
  ds_write_b32 v2, v76 offset:6336
  v_pk_add_f32 v[10:11], v[30:31], v[10:11] neg_lo:[0,1] neg_hi:[0,1]
  v_pk_add_f32 v[78:79], v[20:21], v[78:79] neg_lo:[0,1] neg_hi:[0,1]
  v_cvt_pk_bf16_f32 v9, v10, v11
  v_cvt_pk_bf16_f32 v77, v78, v79
  ds_write_b32 v2, v9 offset:6048
  ds_write_b32 v2, v77 offset:6624
  v_pk_mul_f32 v[14:15], v[26:27], v[22:23] op_sel:[0,0] op_sel_hi:[0,1]
  v_pk_mul_f32 v[16:17], v[28:29], v[22:23] op_sel:[0,0] op_sel_hi:[0,1]
  v_pk_fma_f32 v[30:31], v[26:27], v[22:23], v[14:15] op_sel:[1,1,0] op_sel_hi:[1,0,1] neg_lo:[1,0,0]
  v_pk_fma_f32 v[20:21], v[28:29], v[22:23], v[16:17] op_sel:[1,1,0] op_sel_hi:[1,0,1] neg_lo:[1,0,0]
  v_cvt_pk_bf16_f32 v8, v26, v27
  v_cvt_pk_bf16_f32 v76, v28, v29
  v_lshlrev_b32 v10, 16, v8
  v_lshlrev_b32 v78, 16, v76
  v_and_b32 v11, 0xffff0000, v8
  v_and_b32 v79, 0xffff0000, v76
  ds_write_b32 v2, v8 offset:6912
  ds_write_b32 v2, v76 offset:7488
  v_pk_add_f32 v[10:11], v[26:27], v[10:11] neg_lo:[0,1] neg_hi:[0,1]
  v_pk_add_f32 v[78:79], v[28:29], v[78:79] neg_lo:[0,1] neg_hi:[0,1]
  v_cvt_pk_bf16_f32 v9, v10, v11
  v_cvt_pk_bf16_f32 v77, v78, v79
  ds_write_b32 v2, v9 offset:7200
  ds_write_b32 v2, v77 offset:7776
  v_cvt_pk_bf16_f32 v8, v30, v31
  v_cvt_pk_bf16_f32 v76, v20, v21
  v_lshlrev_b32 v10, 16, v8
  v_lshlrev_b32 v78, 16, v76
  v_and_b32 v11, 0xffff0000, v8
  v_and_b32 v79, 0xffff0000, v76
  ds_write_b32 v2, v8 offset:8064
  ds_write_b32 v2, v76 offset:8640
  v_pk_add_f32 v[10:11], v[30:31], v[10:11] neg_lo:[0,1] neg_hi:[0,1]
  v_pk_add_f32 v[78:79], v[20:21], v[78:79] neg_lo:[0,1] neg_hi:[0,1]
  v_cvt_pk_bf16_f32 v9, v10, v11
  v_cvt_pk_bf16_f32 v77, v78, v79
  ds_write_b32 v2, v9 offset:8352
  ds_write_b32 v2, v77 offset:8928
  s_waitcnt lgkmcnt(0)
  ds_read_b128 v[8:11], v3 offset:0
  ds_read_b128 v[76:79], v3 offset:288
  ds_read_b128 v[24:27], v3 offset:64
  ds_read_b128 v[28:31], v3 offset:352
  s_waitcnt lgkmcnt(2)
  v_mfma_f32_16x16x32_bf16 v[68:71], v[76:79], v[32:35], 0
  v_mfma_f32_16x16x32_bf16 v[68:71], v[8:11], v[48:51], v[68:71]
  v_mfma_f32_16x16x32_bf16 v[68:71], v[8:11], v[32:35], v[68:71]
  s_waitcnt lgkmcnt(0)
  v_mfma_f32_16x16x32_bf16 v[68:71], v[28:31], v[36:39], v[68:71]
  v_mfma_f32_16x16x32_bf16 v[68:71], v[24:27], v[52:55], v[68:71]
  v_mfma_f32_16x16x32_bf16 v[68:71], v[24:27], v[36:39], v[68:71]
  ds_read_b128 v[8:11], v3 offset:128
  ds_read_b128 v[76:79], v3 offset:416
  ds_read_b128 v[24:27], v3 offset:192
  ds_read_b128 v[28:31], v3 offset:480
  s_waitcnt lgkmcnt(2)
  v_mfma_f32_16x16x32_bf16 v[68:71], v[76:79], v[40:43], v[68:71]
  v_mfma_f32_16x16x32_bf16 v[68:71], v[8:11], v[56:59], v[68:71]
  v_mfma_f32_16x16x32_bf16 v[68:71], v[8:11], v[40:43], v[68:71]
  s_waitcnt lgkmcnt(0)
  v_mfma_f32_16x16x32_bf16 v[68:71], v[28:31], v[44:47], v[68:71]
  v_mfma_f32_16x16x32_bf16 v[68:71], v[24:27], v[60:63], v[68:71]
  v_mfma_f32_16x16x32_bf16 v[68:71], v[24:27], v[44:47], v[68:71]
  v_mul_f32 v8, 0x44800000, v4
  v_pk_mul_f32 v[16:17], v[22:23], v[22:23] op_sel:[0,0] op_sel_hi:[0,1]
  v_mul_f32 v9, 0xc4800000, v5
  v_pk_fma_f32 v[18:19], v[22:23], v[22:23], v[16:17] op_sel:[1,1,0] op_sel_hi:[1,0,1] neg_lo:[1,0,0]
  v_exp_f32 v8, v8
  v_fract_f32 v9, v9
  v_cos_f32 v10, v9
  v_sin_f32 v11, v9
  v_mul_f32 v24, v8, v10
  v_mul_f32 v25, v8, v11
  v_pk_mul_f32 v[14:15], v[12:13], v[24:25] op_sel:[0,0] op_sel_hi:[0,1]
  v_pk_fma_f32 v[26:27], v[12:13], v[24:25], v[14:15] op_sel:[1,1,0] op_sel_hi:[1,0,1] neg_lo:[1,0,0]
  v_pk_mul_f32 v[16:17], v[26:27], v[22:23] op_sel:[0,0] op_sel_hi:[0,1]
  v_pk_fma_f32 v[28:29], v[26:27], v[22:23], v[16:17] op_sel:[1,1,0] op_sel_hi:[1,0,1] neg_lo:[1,0,0]
  v_pk_mul_f32 v[14:15], v[26:27], v[18:19] op_sel:[0,0] op_sel_hi:[0,1]
  v_pk_mul_f32 v[16:17], v[28:29], v[18:19] op_sel:[0,0] op_sel_hi:[0,1]
  v_pk_fma_f32 v[30:31], v[26:27], v[18:19], v[14:15] op_sel:[1,1,0] op_sel_hi:[1,0,1] neg_lo:[1,0,0]
  v_pk_fma_f32 v[20:21], v[28:29], v[18:19], v[16:17] op_sel:[1,1,0] op_sel_hi:[1,0,1] neg_lo:[1,0,0]
  v_cvt_pk_bf16_f32 v8, v26, v27
  v_cvt_pk_bf16_f32 v76, v28, v29
  v_lshlrev_b32 v10, 16, v8
  v_lshlrev_b32 v78, 16, v76
  v_and_b32 v11, 0xffff0000, v8
  v_and_b32 v79, 0xffff0000, v76
  ds_write_b32 v2, v8 offset:0
  ds_write_b32 v2, v76 offset:576
  v_pk_add_f32 v[10:11], v[26:27], v[10:11] neg_lo:[0,1] neg_hi:[0,1]
  v_pk_add_f32 v[78:79], v[28:29], v[78:79] neg_lo:[0,1] neg_hi:[0,1]
  v_cvt_pk_bf16_f32 v9, v10, v11
  v_cvt_pk_bf16_f32 v77, v78, v79
  ds_write_b32 v2, v9 offset:288
  ds_write_b32 v2, v77 offset:864
  v_pk_mul_f32 v[14:15], v[30:31], v[18:19] op_sel:[0,0] op_sel_hi:[0,1]
  v_pk_mul_f32 v[16:17], v[20:21], v[18:19] op_sel:[0,0] op_sel_hi:[0,1]
  v_pk_fma_f32 v[26:27], v[30:31], v[18:19], v[14:15] op_sel:[1,1,0] op_sel_hi:[1,0,1] neg_lo:[1,0,0]
  v_pk_fma_f32 v[28:29], v[20:21], v[18:19], v[16:17] op_sel:[1,1,0] op_sel_hi:[1,0,1] neg_lo:[1,0,0]
  v_cvt_pk_bf16_f32 v8, v30, v31
  v_cvt_pk_bf16_f32 v76, v20, v21
  v_lshlrev_b32 v10, 16, v8
  v_lshlrev_b32 v78, 16, v76
  v_and_b32 v11, 0xffff0000, v8
  v_and_b32 v79, 0xffff0000, v76
  ds_write_b32 v2, v8 offset:1152
  ds_write_b32 v2, v76 offset:1728
  v_pk_add_f32 v[10:11], v[30:31], v[10:11] neg_lo:[0,1] neg_hi:[0,1]
  v_pk_add_f32 v[78:79], v[20:21], v[78:79] neg_lo:[0,1] neg_hi:[0,1]
  v_cvt_pk_bf16_f32 v9, v10, v11
  v_cvt_pk_bf16_f32 v77, v78, v79
  ds_write_b32 v2, v9 offset:1440
  ds_write_b32 v2, v77 offset:2016
  v_pk_mul_f32 v[14:15], v[26:27], v[18:19] op_sel:[0,0] op_sel_hi:[0,1]
  v_pk_mul_f32 v[16:17], v[28:29], v[18:19] op_sel:[0,0] op_sel_hi:[0,1]
  v_pk_fma_f32 v[30:31], v[26:27], v[18:19], v[14:15] op_sel:[1,1,0] op_sel_hi:[1,0,1] neg_lo:[1,0,0]
  v_pk_fma_f32 v[20:21], v[28:29], v[18:19], v[16:17] op_sel:[1,1,0] op_sel_hi:[1,0,1] neg_lo:[1,0,0]
  v_cvt_pk_bf16_f32 v8, v26, v27
  v_cvt_pk_bf16_f32 v76, v28, v29
  v_lshlrev_b32 v10, 16, v8
  v_lshlrev_b32 v78, 16, v76
  v_and_b32 v11, 0xffff0000, v8
  v_and_b32 v79, 0xffff0000, v76
  ds_write_b32 v2, v8 offset:2304
  ds_write_b32 v2, v76 offset:2880
  v_pk_add_f32 v[10:11], v[26:27], v[10:11] neg_lo:[0,1] neg_hi:[0,1]
  v_pk_add_f32 v[78:79], v[28:29], v[78:79] neg_lo:[0,1] neg_hi:[0,1]
  v_cvt_pk_bf16_f32 v9, v10, v11
  v_cvt_pk_bf16_f32 v77, v78, v79
  ds_write_b32 v2, v9 offset:2592
  ds_write_b32 v2, v77 offset:3168
  v_pk_mul_f32 v[14:15], v[30:31], v[18:19] op_sel:[0,0] op_sel_hi:[0,1]
  v_pk_fma_f32 v[26:27], v[30:31], v[18:19], v[14:15] op_sel:[1,1,0] op_sel_hi:[1,0,1] neg_lo:[1,0,0]
  v_cvt_pk_bf16_f32 v8, v30, v31
  v_cvt_pk_bf16_f32 v76, v20, v21
  v_lshlrev_b32 v10, 16, v8
  v_lshlrev_b32 v78, 16, v76
  v_and_b32 v11, 0xffff0000, v8
  v_and_b32 v79, 0xffff0000, v76
  ds_write_b32 v2, v8 offset:3456
  ds_write_b32 v2, v76 offset:4032
  v_pk_add_f32 v[10:11], v[30:31], v[10:11] neg_lo:[0,1] neg_hi:[0,1]
  v_pk_add_f32 v[78:79], v[20:21], v[78:79] neg_lo:[0,1] neg_hi:[0,1]
  v_cvt_pk_bf16_f32 v9, v10, v11
  v_cvt_pk_bf16_f32 v77, v78, v79
  ds_write_b32 v2, v9 offset:3744
  ds_write_b32 v2, v77 offset:4320
  v_cvt_pk_bf16_f32 v8, v26, v27
  v_lshlrev_b32 v10, 16, v8
  v_and_b32 v11, 0xffff0000, v8
  ds_write_b32 v2, v8 offset:4608
  v_pk_add_f32 v[10:11], v[26:27], v[10:11] neg_lo:[0,1] neg_hi:[0,1]
  v_cvt_pk_bf16_f32 v9, v10, v11
  ds_write_b32 v2, v9 offset:4896
  s_waitcnt lgkmcnt(0)
  ds_read_b128 v[8:11], v3 offset:0
  ds_read_b128 v[76:79], v3 offset:288
  ds_read_b128 v[24:27], v3 offset:64
  ds_read_b128 v[28:31], v3 offset:352
  s_waitcnt lgkmcnt(2)
  v_mfma_f32_16x16x32_bf16 v[72:75], v[76:79], v[32:35], 0
  v_mfma_f32_16x16x32_bf16 v[72:75], v[8:11], v[48:51], v[72:75]
  v_mfma_f32_16x16x32_bf16 v[72:75], v[8:11], v[32:35], v[72:75]
  s_waitcnt lgkmcnt(0)
  v_mfma_f32_16x16x32_bf16 v[72:75], v[28:31], v[36:39], v[72:75]
  v_mfma_f32_16x16x32_bf16 v[72:75], v[24:27], v[52:55], v[72:75]
  v_mfma_f32_16x16x32_bf16 v[72:75], v[24:27], v[36:39], v[72:75]
  ds_read_b128 v[8:11], v3 offset:128
  ds_read_b128 v[76:79], v3 offset:416
  ds_read_b128 v[24:27], v3 offset:192
  ds_read_b128 v[28:31], v3 offset:480
  s_waitcnt lgkmcnt(2)
  v_mfma_f32_16x16x32_bf16 v[72:75], v[76:79], v[40:43], v[72:75]
  v_mfma_f32_16x16x32_bf16 v[72:75], v[8:11], v[56:59], v[72:75]
  v_mfma_f32_16x16x32_bf16 v[72:75], v[8:11], v[40:43], v[72:75]
  s_waitcnt lgkmcnt(0)
  v_mfma_f32_16x16x32_bf16 v[72:75], v[28:31], v[44:47], v[72:75]
  v_mfma_f32_16x16x32_bf16 v[72:75], v[24:27], v[60:63], v[72:75]
  v_mfma_f32_16x16x32_bf16 v[72:75], v[24:27], v[44:47], v[72:75]
  v_lshlrev_b32 v8, 2, v6
  v_lshl_add_u32 v8, v7, 8, v8
  v_add_u32 v8, s26, v8
  s_waitcnt lgkmcnt(0)
  ds_write_b32 v8, v64 offset:0
  ds_write_b32 v8, v65 offset:64
  ds_write_b32 v8, v66 offset:128
  ds_write_b32 v8, v67 offset:192
  ds_write_b32 v8, v68 offset:1024
  ds_write_b32 v8, v69 offset:1088
  ds_write_b32 v8, v70 offset:1152
  ds_write_b32 v8, v71 offset:1216
  ds_write_b32 v8, v72 offset:2048
  ds_write_b32 v8, v73 offset:2112
  ds_write_b32 v8, v74 offset:2176
  ds_write_b32 v8, v75 offset:2240
  v_max3_f32 v41, |v64|, |v65|, |v66|
  v_max3_f32 v41, v41, |v67|, |v68|
  v_max3_f32 v41, v41, |v69|, |v70|
  v_max3_f32 v41, v41, |v71|, |v72|
  v_max3_f32 v41, v41, |v73|, |v74|
  v_max_f32 v41, v41, |v75|
  s_nop 1
  v_max_f32_dpp v41, v41, v41 row_shr:1 row_mask:0xf bank_mask:0xf bound_ctrl:0
  s_nop 1
  v_max_f32_dpp v41, v41, v41 row_shr:2 row_mask:0xf bank_mask:0xf bound_ctrl:0
  s_nop 1
  v_max_f32_dpp v41, v41, v41 row_shr:4 row_mask:0xf bank_mask:0xf bound_ctrl:0
  s_nop 1
  v_max_f32_dpp v41, v41, v41 row_shr:8 row_mask:0xf bank_mask:0xf bound_ctrl:0
  s_nop 1
  v_max_f32_dpp v41, v41, v41 row_bcast:15 row_mask:0xa bank_mask:0xf
  s_nop 1
  v_max_f32_dpp v41, v41, v41 row_bcast:31 row_mask:0xc bank_mask:0xf
  s_lshl_b32 s9, s8, 2
  v_mov_b32 v42, s9
  s_mov_b32 exec_lo, 0
  s_mov_b32 exec_hi, 0x80000000
  ds_write_b32 v42, v41 offset:27648
  s_mov_b64 exec, -1
  s_branch KA_GATHER
KA_W34:
  s_cmp_eq_u32 s8, 4
  s_cbranch_scc1 KA_W4
  s_cmp_lg_u32 s2, 256
  s_cbranch_scc1 KA_GATHER
  s_memrealtime s[64:65]
  s_waitcnt lgkmcnt(0)
  s_or_b32 s64, s64, 1
  v_mov_b32 v52, 0
  v_mov_b32 v53, s64
  s_mov_b64 exec, 1
  global_store_dword v52, v53, s[60:61] sc1
  s_mov_b64 exec, -1
  s_branch KA_GATHER
KA_W4:
  v_mov_b32 v8, 0
  s_mov_b32 s27, 0
KA_EPOLL:
  s_sleep 32
  global_load_dword v9, v8, s[60:61] sc1
  s_waitcnt vmcnt(0)
  v_readfirstlane_b32 s28, v9
  s_nop 0
  s_cmp_lg_u32 s28, 0
  s_cbranch_scc1 KA_EPOK
  s_add_u32 s27, s27, 1
  s_cmp_lt_u32 s27, 0x10000
  s_cbranch_scc1 KA_EPOLL
KA_EPOK:
  s_barrier
  v_lshlrev_b32 v8, 4, v1
  s_mov_b32 s27, 0
  s_add_u32 s14, s6, 0x00540800
  s_addc_u32 s15, s7, 0
KA_POLL:
  global_load_dwordx4 v[12:15], v8, s[14:15] sc1
  s_waitcnt vmcnt(0)
  v_xor_b32 v12, s28, v12
  v_xor_b32 v13, s28, v13
  v_xor_b32 v14, s28, v14
  v_xor_b32 v15, s28, v15
  v_or3_b32 v12, v12, v13, v14
  v_or_b32 v12, v12, v15
  v_cmp_ne_u32 vcc, 0, v12
  s_nop 0
  s_cmp_eq_u64 vcc, 0
  s_cbranch_scc1 KA_UGO
  s_add_u32 s27, s27, 1
  s_cmp_ge_u32 s27, 0x10000
  s_cbranch_scc1 KA_UGO
  s_sleep 16
  s_branch KA_POLL
KA_UGO:
  s_lshl_b32 s9, s3, 4
  v_mul_u32_u24 v16, 10240, v1
  v_add_u32 v16, s9, v16
  v_add_u32 v9, 655360, v16
  v_add_u32 v10, 1310720, v16
  v_add_u32 v11, 1966080, v16
  global_load_dwordx4 v[64:67], v16, s[6:7] sc1
  global_load_dwordx4 v[68:71], v9, s[6:7] sc1
  global_load_dwordx4 v[72:75], v10, s[6:7] sc1
  global_load_dwordx4 v[76:79], v11, s[6:7] sc1
  v_mov_b32 v56, 0
  v_mov_b32 v57, 0
  v_mov_b32 v58, 0
  v_mov_b32 v59, 0
  v_lshrrev_b32 v13, 2, v1
  v_mul_u32_u24 v14, 4160, v13
  v_mul_u32_u24 v13, 96, v13
  v_and_b32 v15, 3, v1
  v_lshl_add_u32 v13, v15, 4, v13
  v_lshl_add_u32 v14, v15, 4, v14
  s_barrier
  ds_write_b128 v8, v[56:59] offset:16640
  v_cmp_gt_u32 vcc, 32, v1
  s_nop 0
  s_and_saveexec_b64 s[30:31], vcc
  ds_write_b128 v8, v[56:59] offset:17664
  v_cmp_gt_u32 vcc, 16, v1
  s_nop 0
  s_and_b64 exec, exec, vcc
  ds_write_b128 v14, v[56:59] offset:4096
  s_mov_b64 exec, -1
  s_waitcnt vmcnt(0)
  ds_write_b128 v13, v[64:67] offset:18176
  ds_write_b128 v13, v[68:71] offset:19712
  ds_write_b128 v13, v[72:75] offset:21248
  ds_write_b128 v13, v[76:79] offset:22784
  s_waitcnt lgkmcnt(0)
  s_barrier
  s_and_b32 s54, s2, 7
  s_sub_u32 s55, s2, 256
  s_lshr_b32 s55, s55, 3
  s_mul_i32 s56, s55, 24576
  s_mul_i32 s57, s54, 384
  s_add_u32 s56, s56, s57
  v_mul_u32_u24 v16, 43691, v1
  v_lshrrev_b32 v16, 18, v16
  v_mul_u32_u24 v17, 6, v16
  v_sub_u32 v17, v1, v17
  v_mul_u32_u24 v16, 3072, v16
  v_lshl_add_u32 v16, v17, 6, v16
  v_add_u32 v16, s56, v16
  s_mul_i32 s57, s54, 245760
  s_mul_i32 s58, s55, 3072
  s_add_u32 s57, s57, s58
  v_lshlrev_b32 v17, 6, v1
  v_add_u32 v17, s57, v17
  v_cmp_gt_u32 vcc, 48, v1
  s_nop 0
  s_and_saveexec_b64 s[30:31], vcc
  global_load_dword v18, v16, s[48:49]
  global_load_dword v19, v16, s[50:51]
  global_load_dword v20, v17, s[52:53]
  s_mov_b64 exec, s[30:31]
  s_barrier
  s_barrier
  s_endpgm
KA_GATHER:
  s_waitcnt lgkmcnt(0)
  s_barrier
  v_mov_b32 v42, 0
  ds_read_b128 v[44:47], v42 offset:27648
  v_lshlrev_b32 v2, 4, v0
  s_cmp_eq_u32 s8, 3
  s_cbranch_scc1 KA_P1A
  ds_read_b128 v[4:7], v2
  ds_read_b128 v[8:11], v2 offset:9216
  ds_read_b128 v[12:15], v2 offset:18432
  v_lshrrev_b32 v16, 2, v0
  v_and_b32 v17, 3, v0
  v_and_b32 v18, 7, v16
  v_lshrrev_b32 v19, 3, v16
  v_lshl_add_u32 v18, v19, 7, v18
  v_and_b32 v19, 3, v16
  v_bfe_u32 v20, v16, 2, 1
  v_lshlrev_b32 v19, 1, v19
  v_lshl_add_u32 v19, v20, 7, v19
  v_add_u32 v19, 256, v19
  v_and_b32 v20, 1, v16
  v_bfe_u32 v21, v16, 1, 2
  v_lshlrev_b32 v20, 2, v20
  v_lshl_add_u32 v20, v21, 7, v20
  v_add_u32 v20, 512, v20
  v_subrev_u32 v21, 32, v16
  v_lshlrev_b32 v21, 7, v21
  v_add_u32 v21, 1024, v21
  v_cmp_le_u32 vcc, 16, v16
  s_nop 1
  v_cndmask_b32 v18, v18, v19, vcc
  v_cmp_le_u32 vcc, 24, v16
  s_nop 1
  v_cndmask_b32 v18, v18, v20, vcc
  v_cmp_le_u32 vcc, 32, v16
  s_nop 1
  v_cndmask_b32 v18, v18, v21, vcc
  v_lshl_add_u32 v18, v17, 5, v18
  v_lshrrev_b32 v19, 3, v18
  v_add_lshl_u32 v18, v18, v19, 2
KA_P1A:
  s_waitcnt lgkmcnt(0)
  v_add_f32 v41, v44, v45
  v_add_f32 v41, v41, v46
  v_lshrrev_b32 v41, 23, v41
  v_sub_u32 v41, 268, v41
  v_max_i32 v41, 1, v41
  v_min_i32 v41, 253, v41
  v_sub_u32 v42, 254, v41
  v_lshlrev_b32 v41, 23, v41
  v_lshlrev_b32 v42, 23, v42
  s_nop 0
  v_readfirstlane_b32 s19, v42
  s_cmp_eq_u32 s8, 3
  s_cbranch_scc1 KA_P1DONE
  v_add_f32 v4, v4, v8
  v_add_f32 v4, v4, v12
  v_mul_f32 v4, v41, v4
  v_cvt_f16_f32 v4, v4
  v_add_f32 v5, v5, v9
  v_add_f32 v5, v5, v13
  v_mul_f32 v5, v41, v5
  v_cvt_f16_f32 v5, v5
  v_add_f32 v6, v6, v10
  v_add_f32 v6, v6, v14
  v_mul_f32 v6, v41, v6
  v_cvt_f16_f32 v6, v6
  v_add_f32 v7, v7, v11
  v_add_f32 v7, v7, v15
  v_mul_f32 v7, v41, v7
  v_cvt_f16_f32 v7, v7
  v_cmp_gt_u32 vcc, 41, v16
  s_nop 0
  s_and_saveexec_b64 s[30:31], vcc
  ds_write_b32 v18, v4 offset:27904
  ds_write_b32 v18, v5 offset:27940
  ds_write_b32 v18, v6 offset:27976
  ds_write_b32 v18, v7 offset:28012
  s_mov_b64 exec, -1
KA_P1DONE:
  v_lshlrev_b32 v3, 3, v0
  v_sub_u32 v3, 2047, v3
  v_cvt_f32_u32 v3, v3
  s_mov_b32 s29, 0x05040100
  v_add_f32 v4, 0x80000000, v3
  v_add_f32 v5, 0xbf800000, v3
  v_cvt_pk_bf16_f32 v4, v4, v5
  v_and_b32 v5, 0xffff0000, v4
  v_lshlrev_b32 v4, 16, v4
  v_cvt_u32_f32 v5, v5
  v_cvt_u32_f32 v4, v4
  v_lshrrev_b32 v7, 3, v5
  v_lshrrev_b32 v6, 3, v4
  v_add_lshl_u32 v9, v5, v7, 2
  v_add_lshl_u32 v8, v4, v6, 2
  v_add_f32 v4, 0xc0000000, v3
  v_add_f32 v5, 0xc0400000, v3
  v_cvt_pk_bf16_f32 v4, v4, v5
  v_and_b32 v5, 0xffff0000, v4
  v_lshlrev_b32 v4, 16, v4
  v_cvt_u32_f32 v5, v5
  v_cvt_u32_f32 v4, v4
  v_lshrrev_b32 v7, 3, v5
  v_lshrrev_b32 v6, 3, v4
  v_add_lshl_u32 v11, v5, v7, 2
  v_add_lshl_u32 v10, v4, v6, 2
  v_add_f32 v4, 0xc0800000, v3
  v_add_f32 v5, 0xc0a00000, v3
  v_cvt_pk_bf16_f32 v4, v4, v5
  v_and_b32 v5, 0xffff0000, v4
  v_lshlrev_b32 v4, 16, v4
  v_cvt_u32_f32 v5, v5
  v_cvt_u32_f32 v4, v4
  v_lshrrev_b32 v7, 3, v5
  v_lshrrev_b32 v6, 3, v4
  v_add_lshl_u32 v13, v5, v7, 2
  v_add_lshl_u32 v12, v4, v6, 2
  v_add_f32 v4, 0xc0c00000, v3
  v_add_f32 v5, 0xc0e00000, v3
  v_cvt_pk_bf16_f32 v4, v4, v5
  v_and_b32 v5, 0xffff0000, v4
  v_lshlrev_b32 v4, 16, v4
  v_cvt_u32_f32 v5, v5
  v_cvt_u32_f32 v4, v4
  v_lshrrev_b32 v7, 3, v5
  v_lshrrev_b32 v6, 3, v4
  v_add_lshl_u32 v15, v5, v7, 2
  v_add_lshl_u32 v14, v4, v6, 2
  v_add_f32 v4, 0xc1000000, v3
  v_add_f32 v5, 0xc1100000, v3
  v_cvt_pk_bf16_f32 v4, v4, v5
  v_and_b32 v5, 0xffff0000, v4
  v_lshlrev_b32 v4, 16, v4
  v_cvt_u32_f32 v5, v5
  v_cvt_u32_f32 v4, v4
  v_lshrrev_b32 v7, 3, v5
  v_lshrrev_b32 v6, 3, v4
  v_add_lshl_u32 v17, v5, v7, 2
  v_add_lshl_u32 v16, v4, v6, 2
  v_add_f32 v4, 0xc1200000, v3
  v_add_f32 v5, 0xc1300000, v3
  v_cvt_pk_bf16_f32 v4, v4, v5
  v_and_b32 v5, 0xffff0000, v4
  v_lshlrev_b32 v4, 16, v4
  v_cvt_u32_f32 v5, v5
  v_cvt_u32_f32 v4, v4
  v_lshrrev_b32 v7, 3, v5
  v_lshrrev_b32 v6, 3, v4
  v_add_lshl_u32 v19, v5, v7, 2
  v_add_lshl_u32 v18, v4, v6, 2
  s_waitcnt lgkmcnt(0)
  s_barrier
  ds_read_b32 v20, v8 offset:27904
  ds_read_b32 v21, v9 offset:27904
  ds_read_b32 v22, v10 offset:27904
  ds_read_b32 v23, v11 offset:27904
  ds_read_b32 v24, v12 offset:27904
  ds_read_b32 v25, v13 offset:27904
  ds_read_b32 v26, v14 offset:27904
  ds_read_b32 v27, v15 offset:27904
  ds_read_b32 v28, v16 offset:27904
  ds_read_b32 v29, v17 offset:27904
  ds_read_b32 v30, v18 offset:27904
  s_waitcnt lgkmcnt(0)
  v_perm_b32 v48, v21, v20, s29
  v_perm_b32 v49, v23, v22, s29
  v_perm_b32 v50, v25, v24, s29
  v_perm_b32 v51, v27, v26, s29
  v_perm_b32 v52, v22, v21, s29
  v_perm_b32 v53, v24, v23, s29
  v_perm_b32 v54, v26, v25, s29
  v_perm_b32 v55, v28, v27, s29
  v_perm_b32 v56, v23, v22, s29
  v_perm_b32 v57, v25, v24, s29
  v_perm_b32 v58, v27, v26, s29
  v_perm_b32 v59, v29, v28, s29
  v_perm_b32 v60, v24, v23, s29
  v_perm_b32 v61, v26, v25, s29
  v_perm_b32 v62, v28, v27, s29
  v_perm_b32 v63, v30, v29, s29
  ds_write_b128 v2, v[48:51] offset:0
  ds_write_b128 v2, v[52:55] offset:4160
  ds_write_b128 v2, v[56:59] offset:8320
  ds_write_b128 v2, v[60:63] offset:12480
  s_cmp_lg_u32 s8, 3
  s_cbranch_scc1 KA_NOU
  v_mov_b32 v42, 0
  s_mov_b64 exec, 1
  ds_write_b16 v42, v42 offset:8254
  ds_write_b32 v42, v42 offset:12412
  ds_write_b16 v42, v42 offset:16570
  ds_write_b32 v42, v42 offset:16572
  s_mov_b64 exec, -1
KA_NOU:
  v_lshrrev_b32 v13, 2, v0
  v_mul_u32_u24 v15, 144, v13
  v_mul_u32_u24 v13, 96, v13
  v_and_b32 v14, 3, v0
  v_lshl_add_u32 v13, v14, 4, v13
  v_lshl_add_u32 v15, v14, 5, v15
  v_and_b32 v2, 15, v1
  v_lshrrev_b32 v3, 4, v1
  v_and_b32 v4, 3, v1
  v_sub_u32 v4, 3, v4
  v_mul_u32_u24 v4, 4160, v4
  v_lshrrev_b32 v5, 2, v2
  v_lshlrev_b32 v6, 1, v3
  v_sub_u32 v5, v6, v5
  v_lshl_add_u32 v4, v5, 3, v4
  s_lshl_b32 s17, s8, 8
  s_sub_u32 s17, 792, s17
  v_add_u32 v4, s17, v4
  s_mul_i32 s17, s8, 384
  s_sub_u32 s17, 17888, s17
  v_mul_u32_u24 v5, 96, v2
  v_lshl_add_u32 v5, v3, 4, v5
  v_add_u32 v5, s17, v5
  s_mul_i32 s17, s8, 9216
  v_mul_u32_u24 v6, 144, v2
  v_lshl_add_u32 v6, v3, 4, v6
  v_add_u32 v6, s17, v6
  s_and_b32 s9, s3, 1
  s_lshl_b32 s9, s9, 4
  s_lshr_b32 s62, s62, s9
  s_lshl_b32 s62, s62, 16
  v_mov_b32 v12, s62
  s_add_u32 s14, s6, 0x002a0000
  s_addc_u32 s15, s7, 0
  s_waitcnt lgkmcnt(0)
  s_barrier
KA_CONV:
  ds_read_b128 v[32:35], v5 offset:288
  ds_read_b64 v[16:17], v4 offset:3296
  ds_read_b64 v[18:19], v4 offset:3304
  ds_read_b64 v[20:21], v4 offset:3264
  ds_read_b64 v[22:23], v4 offset:3272
  ds_read_b128 v[36:39], v5 offset:1824
  ds_read_b128 v[40:43], v5 offset:3360
  ds_read_b128 v[44:47], v5 offset:4896
  ds_read_b64 v[24:25], v4 offset:2272
  ds_read_b64 v[26:27], v4 offset:2280
  ds_read_b64 v[28:29], v4 offset:2240
  ds_read_b64 v[30:31], v4 offset:2248
  s_waitcnt lgkmcnt(9)
  v_mfma_f32_16x16x32_f16 v[48:51], v[16:19], v[32:35], 0
  s_waitcnt lgkmcnt(7)
  v_mfma_f32_16x16x32_f16 v[52:55], v[20:23], v[32:35], 0
  s_waitcnt lgkmcnt(6)
  v_mfma_f32_16x16x32_f16 v[56:59], v[16:19], v[36:39], 0
  v_mfma_f32_16x16x32_f16 v[60:63], v[20:23], v[36:39], 0
  s_waitcnt lgkmcnt(5)
  v_mfma_f32_16x16x32_f16 v[64:67], v[16:19], v[40:43], 0
  v_mfma_f32_16x16x32_f16 v[68:71], v[20:23], v[40:43], 0
  s_waitcnt lgkmcnt(4)
  v_mfma_f32_16x16x32_f16 v[72:75], v[16:19], v[44:47], 0
  v_mfma_f32_16x16x32_f16 v[76:79], v[20:23], v[44:47], 0
  ds_read_b64 v[16:17], v4 offset:1248
  ds_read_b64 v[18:19], v4 offset:1256
  ds_read_b64 v[20:21], v4 offset:1216
  ds_read_b64 v[22:23], v4 offset:1224
  ds_read_b128 v[8:11], v5 offset:192
  ds_read_b128 v[44:47], v5 offset:4800
  s_waitcnt lgkmcnt(8)
  v_mfma_f32_16x16x32_f16 v[56:59], v[24:27], v[32:35], v[56:59]
  s_waitcnt lgkmcnt(6)
  v_mfma_f32_16x16x32_f16 v[60:63], v[28:31], v[32:35], v[60:63]
  v_mfma_f32_16x16x32_f16 v[64:67], v[24:27], v[36:39], v[64:67]
  v_mfma_f32_16x16x32_f16 v[68:71], v[28:31], v[36:39], v[68:71]
  v_mfma_f32_16x16x32_f16 v[72:75], v[24:27], v[40:43], v[72:75]
  v_mfma_f32_16x16x32_f16 v[76:79], v[28:31], v[40:43], v[76:79]
  ds_read_b64 v[24:25], v4 offset:224
  ds_read_b64 v[26:27], v4 offset:232
  ds_read_b64 v[28:29], v4 offset:192
  ds_read_b64 v[30:31], v4 offset:200
  ds_read_b128 v[40:43], v5 offset:3264
  s_waitcnt lgkmcnt(9)
  v_mfma_f32_16x16x32_f16 v[64:67], v[16:19], v[32:35], v[64:67]
  s_waitcnt lgkmcnt(7)
  v_mfma_f32_16x16x32_f16 v[68:71], v[20:23], v[32:35], v[68:71]
  v_mfma_f32_16x16x32_f16 v[72:75], v[16:19], v[36:39], v[72:75]
  v_mfma_f32_16x16x32_f16 v[76:79], v[20:23], v[36:39], v[76:79]
  ds_read_b64 v[16:17], v4 offset:3232
  ds_read_b64 v[18:19], v4 offset:3240
  ds_read_b64 v[20:21], v4 offset:3200
  ds_read_b64 v[22:23], v4 offset:3208
  ds_read_b128 v[36:39], v5 offset:1728
  s_waitcnt lgkmcnt(8)
  v_mfma_f32_16x16x32_f16 v[72:75], v[24:27], v[32:35], v[72:75]
  s_waitcnt lgkmcnt(6)
  v_mfma_f32_16x16x32_f16 v[76:79], v[28:31], v[32:35], v[76:79]
  ds_read_b64 v[24:25], v4 offset:2208
  ds_read_b64 v[26:27], v4 offset:2216
  ds_read_b64 v[28:29], v4 offset:2176
  ds_read_b64 v[30:31], v4 offset:2184
  s_waitcnt lgkmcnt(7)
  v_mfma_f32_16x16x32_f16 v[48:51], v[16:19], v[8:11], v[48:51]
  s_waitcnt lgkmcnt(5)
  v_mfma_f32_16x16x32_f16 v[52:55], v[20:23], v[8:11], v[52:55]
  s_waitcnt lgkmcnt(4)
  v_mfma_f32_16x16x32_f16 v[56:59], v[16:19], v[36:39], v[56:59]
  v_mfma_f32_16x16x32_f16 v[60:63], v[20:23], v[36:39], v[60:63]
  v_mfma_f32_16x16x32_f16 v[64:67], v[16:19], v[40:43], v[64:67]
  v_mfma_f32_16x16x32_f16 v[68:71], v[20:23], v[40:43], v[68:71]
  v_mfma_f32_16x16x32_f16 v[72:75], v[16:19], v[44:47], v[72:75]
  v_mfma_f32_16x16x32_f16 v[76:79], v[20:23], v[44:47], v[76:79]
  ds_read_b64 v[16:17], v4 offset:1184
  ds_read_b64 v[18:19], v4 offset:1192
  ds_read_b64 v[20:21], v4 offset:1152
  ds_read_b64 v[22:23], v4 offset:1160
  ds_read_b128 v[32:35], v5 offset:96
  ds_read_b128 v[44:47], v5 offset:4704
  s_waitcnt lgkmcnt(8)
  v_mfma_f32_16x16x32_f16 v[56:59], v[24:27], v[8:11], v[56:59]
  s_waitcnt lgkmcnt(6)
  v_mfma_f32_16x16x32_f16 v[60:63], v[28:31], v[8:11], v[60:63]
  v_mfma_f32_16x16x32_f16 v[64:67], v[24:27], v[36:39], v[64:67]
  v_mfma_f32_16x16x32_f16 v[68:71], v[28:31], v[36:39], v[68:71]
  v_mfma_f32_16x16x32_f16 v[72:75], v[24:27], v[40:43], v[72:75]
  v_mfma_f32_16x16x32_f16 v[76:79], v[28:31], v[40:43], v[76:79]
  ds_read_b64 v[24:25], v4 offset:160
  ds_read_b64 v[26:27], v4 offset:168
  ds_read_b64 v[28:29], v4 offset:128
  ds_read_b64 v[30:31], v4 offset:136
  ds_read_b128 v[40:43], v5 offset:3168
  s_waitcnt lgkmcnt(9)
  v_mfma_f32_16x16x32_f16 v[64:67], v[16:19], v[8:11], v[64:67]
  s_waitcnt lgkmcnt(7)
  v_mfma_f32_16x16x32_f16 v[68:71], v[20:23], v[8:11], v[68:71]
  v_mfma_f32_16x16x32_f16 v[72:75], v[16:19], v[36:39], v[72:75]
  v_mfma_f32_16x16x32_f16 v[76:79], v[20:23], v[36:39], v[76:79]
  ds_read_b64 v[16:17], v4 offset:3168
  ds_read_b64 v[18:19], v4 offset:3176
  ds_read_b64 v[20:21], v4 offset:3136
  ds_read_b64 v[22:23], v4 offset:3144
  ds_read_b128 v[36:39], v5 offset:1632
  s_waitcnt lgkmcnt(8)
  v_mfma_f32_16x16x32_f16 v[72:75], v[24:27], v[8:11], v[72:75]
  s_waitcnt lgkmcnt(6)
  v_mfma_f32_16x16x32_f16 v[76:79], v[28:31], v[8:11], v[76:79]
  ds_read_b64 v[24:25], v4 offset:2144
  ds_read_b64 v[26:27], v4 offset:2152
  ds_read_b64 v[28:29], v4 offset:2112
  ds_read_b64 v[30:31], v4 offset:2120
  s_waitcnt lgkmcnt(7)
  v_mfma_f32_16x16x32_f16 v[48:51], v[16:19], v[32:35], v[48:51]
  s_waitcnt lgkmcnt(5)
  v_mfma_f32_16x16x32_f16 v[52:55], v[20:23], v[32:35], v[52:55]
  s_waitcnt lgkmcnt(4)
  v_mfma_f32_16x16x32_f16 v[56:59], v[16:19], v[36:39], v[56:59]
  v_mfma_f32_16x16x32_f16 v[60:63], v[20:23], v[36:39], v[60:63]
  v_mfma_f32_16x16x32_f16 v[64:67], v[16:19], v[40:43], v[64:67]
  v_mfma_f32_16x16x32_f16 v[68:71], v[20:23], v[40:43], v[68:71]
  v_mfma_f32_16x16x32_f16 v[72:75], v[16:19], v[44:47], v[72:75]
  v_mfma_f32_16x16x32_f16 v[76:79], v[20:23], v[44:47], v[76:79]
  ds_read_b64 v[16:17], v4 offset:1120
  ds_read_b64 v[18:19], v4 offset:1128
  ds_read_b64 v[20:21], v4 offset:1088
  ds_read_b64 v[22:23], v4 offset:1096
  ds_read_b128 v[8:11], v5 offset:0
  ds_read_b128 v[44:47], v5 offset:4608
  s_waitcnt lgkmcnt(8)
  v_mfma_f32_16x16x32_f16 v[56:59], v[24:27], v[32:35], v[56:59]
  s_waitcnt lgkmcnt(6)
  v_mfma_f32_16x16x32_f16 v[60:63], v[28:31], v[32:35], v[60:63]
  v_mfma_f32_16x16x32_f16 v[64:67], v[24:27], v[36:39], v[64:67]
  v_mfma_f32_16x16x32_f16 v[68:71], v[28:31], v[36:39], v[68:71]
  v_mfma_f32_16x16x32_f16 v[72:75], v[24:27], v[40:43], v[72:75]
  v_mfma_f32_16x16x32_f16 v[76:79], v[28:31], v[40:43], v[76:79]
  ds_read_b64 v[24:25], v4 offset:96
  ds_read_b64 v[26:27], v4 offset:104
  ds_read_b64 v[28:29], v4 offset:64
  ds_read_b64 v[30:31], v4 offset:72
  ds_read_b128 v[40:43], v5 offset:3072
  s_waitcnt lgkmcnt(9)
  v_mfma_f32_16x16x32_f16 v[64:67], v[16:19], v[32:35], v[64:67]
  s_waitcnt lgkmcnt(7)
  v_mfma_f32_16x16x32_f16 v[68:71], v[20:23], v[32:35], v[68:71]
  v_mfma_f32_16x16x32_f16 v[72:75], v[16:19], v[36:39], v[72:75]
  v_mfma_f32_16x16x32_f16 v[76:79], v[20:23], v[36:39], v[76:79]
  ds_read_b64 v[16:17], v4 offset:3104
  ds_read_b64 v[18:19], v4 offset:3112
  ds_read_b64 v[20:21], v4 offset:3072
  ds_read_b64 v[22:23], v4 offset:3080
  ds_read_b128 v[36:39], v5 offset:1536
  s_waitcnt lgkmcnt(8)
  v_mfma_f32_16x16x32_f16 v[72:75], v[24:27], v[32:35], v[72:75]
  s_waitcnt lgkmcnt(6)
  v_mfma_f32_16x16x32_f16 v[76:79], v[28:31], v[32:35], v[76:79]
  ds_read_b64 v[24:25], v4 offset:2080
  ds_read_b64 v[26:27], v4 offset:2088
  ds_read_b64 v[28:29], v4 offset:2048
  ds_read_b64 v[30:31], v4 offset:2056
  s_waitcnt lgkmcnt(7)
  v_mfma_f32_16x16x32_f16 v[48:51], v[16:19], v[8:11], v[48:51]
  s_waitcnt lgkmcnt(5)
  v_mfma_f32_16x16x32_f16 v[52:55], v[20:23], v[8:11], v[52:55]
  s_waitcnt lgkmcnt(4)
  v_mfma_f32_16x16x32_f16 v[56:59], v[16:19], v[36:39], v[56:59]
  v_mfma_f32_16x16x32_f16 v[60:63], v[20:23], v[36:39], v[60:63]
  v_mfma_f32_16x16x32_f16 v[64:67], v[16:19], v[40:43], v[64:67]
  v_mfma_f32_16x16x32_f16 v[68:71], v[20:23], v[40:43], v[68:71]
  v_mfma_f32_16x16x32_f16 v[72:75], v[16:19], v[44:47], v[72:75]
  v_mfma_f32_16x16x32_f16 v[76:79], v[20:23], v[44:47], v[76:79]
  ds_read_b64 v[16:17], v4 offset:1056
  ds_read_b64 v[18:19], v4 offset:1064
  ds_read_b64 v[20:21], v4 offset:1024
  ds_read_b64 v[22:23], v4 offset:1032
  s_waitcnt lgkmcnt(6)
  v_mfma_f32_16x16x32_f16 v[56:59], v[24:27], v[8:11], v[56:59]
  s_waitcnt lgkmcnt(4)
  v_mfma_f32_16x16x32_f16 v[60:63], v[28:31], v[8:11], v[60:63]
  v_mfma_f32_16x16x32_f16 v[64:67], v[24:27], v[36:39], v[64:67]
  v_mfma_f32_16x16x32_f16 v[68:71], v[28:31], v[36:39], v[68:71]
  v_mfma_f32_16x16x32_f16 v[72:75], v[24:27], v[40:43], v[72:75]
  v_mfma_f32_16x16x32_f16 v[76:79], v[28:31], v[40:43], v[76:79]
  ds_read_b64 v[24:25], v4 offset:32
  ds_read_b64 v[26:27], v4 offset:40
  ds_read_b64 v[28:29], v4 offset:0
  ds_read_b64 v[30:31], v4 offset:8
  s_waitcnt lgkmcnt(6)
  v_mfma_f32_16x16x32_f16 v[64:67], v[16:19], v[8:11], v[64:67]
  s_waitcnt lgkmcnt(4)
  v_mfma_f32_16x16x32_f16 v[68:71], v[20:23], v[8:11], v[68:71]
  v_mfma_f32_16x16x32_f16 v[72:75], v[16:19], v[36:39], v[72:75]
  v_mfma_f32_16x16x32_f16 v[76:79], v[20:23], v[36:39], v[76:79]
  s_waitcnt lgkmcnt(2)
  v_mfma_f32_16x16x32_f16 v[72:75], v[24:27], v[8:11], v[72:75]
  s_waitcnt lgkmcnt(0)
  v_mfma_f32_16x16x32_f16 v[76:79], v[28:31], v[8:11], v[76:79]
  ds_read_b128 v[8:11], v13 offset:18176
  s_waitcnt lgkmcnt(0)
  s_barrier
  ds_write_b128 v6, v[48:51] offset:0
  ds_write_b128 v6, v[52:55] offset:64
  ds_write_b128 v6, v[56:59] offset:2304
  ds_write_b128 v6, v[60:63] offset:2368
  ds_write_b128 v6, v[64:67] offset:4608
  ds_write_b128 v6, v[68:71] offset:4672
  ds_write_b128 v6, v[72:75] offset:6912
  ds_write_b128 v6, v[76:79] offset:6976
  s_waitcnt lgkmcnt(0)
  s_barrier
  ds_read_b128 v[16:19], v15 offset:0
  ds_read_b128 v[20:23], v15 offset:16
  ds_read_b128 v[24:27], v15 offset:9216
  ds_read_b128 v[28:31], v15 offset:9232
  ds_read_b128 v[32:35], v15 offset:18432
  ds_read_b128 v[36:39], v15 offset:18448
  ds_read_b128 v[40:43], v15 offset:27648
  ds_read_b128 v[44:47], v15 offset:27664
  v_cvt_f32_f16 v52, v8
  v_lshrrev_b32 v53, 16, v8
  v_cvt_f32_f16 v53, v53
  v_mul_f32 v52, v12, v52
  v_mul_f32 v53, v12, v53
  v_cvt_pk_bf16_f32 v48, v52, v53
  v_cvt_f32_f16 v52, v9
  v_lshrrev_b32 v53, 16, v9
  v_cvt_f32_f16 v53, v53
  v_mul_f32 v52, v12, v52
  v_mul_f32 v53, v12, v53
  v_cvt_pk_bf16_f32 v49, v52, v53
  v_cvt_f32_f16 v52, v10
  v_lshrrev_b32 v53, 16, v10
  v_cvt_f32_f16 v53, v53
  v_mul_f32 v52, v12, v52
  v_mul_f32 v53, v12, v53
  v_cvt_pk_bf16_f32 v50, v52, v53
  v_cvt_f32_f16 v52, v11
  v_lshrrev_b32 v53, 16, v11
  v_cvt_f32_f16 v53, v53
  v_mul_f32 v52, v12, v52
  v_mul_f32 v53, v12, v53
  v_cvt_pk_bf16_f32 v51, v52, v53
  s_waitcnt lgkmcnt(0)
  v_add_f32 v16, v16, v24
  v_add_f32 v32, v32, v40
  v_add_f32 v16, v16, v32
  v_mul_f32 v16, s19, v16
  v_add_f32 v17, v17, v25
  v_add_f32 v33, v33, v41
  v_add_f32 v17, v17, v33
  v_mul_f32 v17, s19, v17
  v_add_f32 v18, v18, v26
  v_add_f32 v34, v34, v42
  v_add_f32 v18, v18, v34
  v_mul_f32 v18, s19, v18
  v_add_f32 v19, v19, v27
  v_add_f32 v35, v35, v43
  v_add_f32 v19, v19, v35
  v_mul_f32 v19, s19, v19
  v_add_f32 v20, v20, v28
  v_add_f32 v36, v36, v44
  v_add_f32 v20, v20, v36
  v_mul_f32 v20, s19, v20
  v_add_f32 v21, v21, v29
  v_add_f32 v37, v37, v45
  v_add_f32 v21, v21, v37
  v_mul_f32 v21, s19, v21
  v_add_f32 v22, v22, v30
  v_add_f32 v38, v38, v46
  v_add_f32 v22, v22, v38
  v_mul_f32 v22, s19, v22
  v_add_f32 v23, v23, v31
  v_add_f32 v39, v39, v47
  v_add_f32 v23, v23, v39
  v_mul_f32 v23, s19, v23
  v_cvt_pk_bf16_f32 v55, v16, v17
  v_lshlrev_b32 v52, 16, v48
  v_and_b32 v53, 0xffff0000, v48
  v_lshlrev_b32 v56, 16, v55
  v_and_b32 v57, 0xffff0000, v55
  v_add_f32 v52, v52, v56
  v_add_f32 v53, v53, v57
  v_cvt_pk_bf16_f32 v60, v52, v53
  v_cvt_pk_bf16_f32 v55, v18, v19
  v_lshlrev_b32 v52, 16, v49
  v_and_b32 v53, 0xffff0000, v49
  v_lshlrev_b32 v56, 16, v55
  v_and_b32 v57, 0xffff0000, v55
  v_add_f32 v52, v52, v56
  v_add_f32 v53, v53, v57
  v_cvt_pk_bf16_f32 v61, v52, v53
  v_cvt_pk_bf16_f32 v55, v20, v21
  v_lshlrev_b32 v52, 16, v50
  v_and_b32 v53, 0xffff0000, v50
  v_lshlrev_b32 v56, 16, v55
  v_and_b32 v57, 0xffff0000, v55
  v_add_f32 v52, v52, v56
  v_add_f32 v53, v53, v57
  v_cvt_pk_bf16_f32 v62, v52, v53
  v_cvt_pk_bf16_f32 v55, v22, v23
  v_lshlrev_b32 v52, 16, v51
  v_and_b32 v53, 0xffff0000, v51
  v_lshlrev_b32 v56, 16, v55
  v_and_b32 v57, 0xffff0000, v55
  v_add_f32 v52, v52, v56
  v_add_f32 v53, v53, v57
  v_cvt_pk_bf16_f32 v63, v52, v53
  s_lshl_b32 s9, s3, 4
  v_mul_u32_u24 v2, 10240, v0
  v_add_u32 v3, s9, v2
  global_store_dwordx4 v3, v[60:63], s[14:15]
KA_END:
  s_endpgm
.globl kb_kernel
.p2align 8
.type kb_kernel,@function
kb_kernel:
  s_cmp_ge_u32 s2, 352
  s_cbranch_scc1 KB_END
  s_cmp_ge_u32 s2, 256
  s_cbranch_scc1 KB_FFN
  s_load_dwordx2 s[6:7], s[0:1], 128
  s_load_dwordx2 s[4:5], s[0:1], 0
  s_load_dwordx2 s[10:11], s[0:1], 80
  s_load_dwordx2 s[12:13], s[0:1], 112
  v_lshrrev_b32 v63, 6, v0
  s_nop 0
  v_readfirstlane_b32 s8, v63
  v_and_b32 v1, 63, v0
  s_mul_i32 s3, s2, 10240
  v_lshlrev_b32 v2, 2, v0
  v_add_u32 v60, s3, v2
  v_add_u32 v61, 5120, v60
  s_waitcnt lgkmcnt(0)
  s_add_u32 s14, s6, 0x002a0000
  s_addc_u32 s15, s7, 0
  global_load_dword v4, v60, s[4:5] offset:0
  global_load_dword v5, v60, s[4:5] offset:1280
  global_load_dword v6, v60, s[4:5] offset:2560
  global_load_dword v7, v60, s[4:5] offset:3840
  global_load_dword v8, v61, s[4:5] offset:0
  global_load_dword v9, v61, s[4:5] offset:1280
  global_load_dword v10, v61, s[4:5] offset:2560
  global_load_dword v11, v61, s[4:5] offset:3840
  v_lshlrev_b32 v3, 5, v0
  v_add_u32 v3, s3, v3
  global_load_dwordx4 v[44:47], v3, s[14:15]
  global_load_dwordx4 v[48:51], v3, s[14:15] offset:16
  global_load_dword v52, v2, s[10:11]
  s_waitcnt vmcnt(0)
  v_lshlrev_b32 v36, 16, v44
  v_lshlrev_b32 v37, 16, v48
  v_lshlrev_b32 v38, 16, v4
  v_and_b32 v39, 0xffff0000, v4
  v_add_f32 v36, v36, v38
  v_add_f32 v37, v37, v39
  v_cvt_pk_bf16_f32 v64, v36, v37
  v_lshlrev_b32 v12, 16, v64
  v_and_b32 v13, 0xffff0000, v64
  v_and_b32 v36, 0xffff0000, v44
  v_and_b32 v37, 0xffff0000, v48
  v_lshlrev_b32 v38, 16, v5
  v_and_b32 v39, 0xffff0000, v5
  v_add_f32 v36, v36, v38
  v_add_f32 v37, v37, v39
  v_cvt_pk_bf16_f32 v65, v36, v37
  v_lshlrev_b32 v14, 16, v65
  v_and_b32 v15, 0xffff0000, v65
  v_lshlrev_b32 v36, 16, v45
  v_lshlrev_b32 v37, 16, v49
  v_lshlrev_b32 v38, 16, v6
  v_and_b32 v39, 0xffff0000, v6
  v_add_f32 v36, v36, v38
  v_add_f32 v37, v37, v39
  v_cvt_pk_bf16_f32 v66, v36, v37
  v_lshlrev_b32 v16, 16, v66
  v_and_b32 v17, 0xffff0000, v66
  v_and_b32 v36, 0xffff0000, v45
  v_and_b32 v37, 0xffff0000, v49
  v_lshlrev_b32 v38, 16, v7
  v_and_b32 v39, 0xffff0000, v7
  v_add_f32 v36, v36, v38
  v_add_f32 v37, v37, v39
  v_cvt_pk_bf16_f32 v67, v36, v37
  v_lshlrev_b32 v18, 16, v67
  v_and_b32 v19, 0xffff0000, v67
  v_lshlrev_b32 v36, 16, v46
  v_lshlrev_b32 v37, 16, v50
  v_lshlrev_b32 v38, 16, v8
  v_and_b32 v39, 0xffff0000, v8
  v_add_f32 v36, v36, v38
  v_add_f32 v37, v37, v39
  v_cvt_pk_bf16_f32 v68, v36, v37
  v_lshlrev_b32 v20, 16, v68
  v_and_b32 v21, 0xffff0000, v68
  v_and_b32 v36, 0xffff0000, v46
  v_and_b32 v37, 0xffff0000, v50
  v_lshlrev_b32 v38, 16, v9
  v_and_b32 v39, 0xffff0000, v9
  v_add_f32 v36, v36, v38
  v_add_f32 v37, v37, v39
  v_cvt_pk_bf16_f32 v69, v36, v37
  v_lshlrev_b32 v22, 16, v69
  v_and_b32 v23, 0xffff0000, v69
  v_lshlrev_b32 v36, 16, v47
  v_lshlrev_b32 v37, 16, v51
  v_lshlrev_b32 v38, 16, v10
  v_and_b32 v39, 0xffff0000, v10
  v_add_f32 v36, v36, v38
  v_add_f32 v37, v37, v39
  v_cvt_pk_bf16_f32 v70, v36, v37
  v_lshlrev_b32 v24, 16, v70
  v_and_b32 v25, 0xffff0000, v70
  v_and_b32 v36, 0xffff0000, v47
  v_and_b32 v37, 0xffff0000, v51
  v_lshlrev_b32 v38, 16, v11
  v_and_b32 v39, 0xffff0000, v11
  v_add_f32 v36, v36, v38
  v_add_f32 v37, v37, v39
  v_cvt_pk_bf16_f32 v71, v36, v37
  v_lshlrev_b32 v26, 16, v71
  v_and_b32 v27, 0xffff0000, v71
  v_add_f32 v28, v12, v13
  v_add_f32 v29, v14, v15
  v_add_f32 v30, v16, v17
  v_add_f32 v31, v18, v19
  v_add_f32 v32, v20, v21
  v_add_f32 v33, v22, v23
  v_add_f32 v34, v24, v25
  v_add_f32 v35, v26, v27
  v_add_f32_dpp v28, v28, v28 row_shr:1 row_mask:0xf bank_mask:0xf bound_ctrl:0
  v_add_f32_dpp v29, v29, v29 row_shr:1 row_mask:0xf bank_mask:0xf bound_ctrl:0
  v_add_f32_dpp v30, v30, v30 row_shr:1 row_mask:0xf bank_mask:0xf bound_ctrl:0
  v_add_f32_dpp v31, v31, v31 row_shr:1 row_mask:0xf bank_mask:0xf bound_ctrl:0
  v_add_f32_dpp v32, v32, v32 row_shr:1 row_mask:0xf bank_mask:0xf bound_ctrl:0
  v_add_f32_dpp v33, v33, v33 row_shr:1 row_mask:0xf bank_mask:0xf bound_ctrl:0
  v_add_f32_dpp v34, v34, v34 row_shr:1 row_mask:0xf bank_mask:0xf bound_ctrl:0
  v_add_f32_dpp v35, v35, v35 row_shr:1 row_mask:0xf bank_mask:0xf bound_ctrl:0
  v_add_f32_dpp v28, v28, v28 row_shr:2 row_mask:0xf bank_mask:0xf bound_ctrl:0
  v_add_f32_dpp v29, v29, v29 row_shr:2 row_mask:0xf bank_mask:0xf bound_ctrl:0
  v_add_f32_dpp v30, v30, v30 row_shr:2 row_mask:0xf bank_mask:0xf bound_ctrl:0
  v_add_f32_dpp v31, v31, v31 row_shr:2 row_mask:0xf bank_mask:0xf bound_ctrl:0
  v_add_f32_dpp v32, v32, v32 row_shr:2 row_mask:0xf bank_mask:0xf bound_ctrl:0
  v_add_f32_dpp v33, v33, v33 row_shr:2 row_mask:0xf bank_mask:0xf bound_ctrl:0
  v_add_f32_dpp v34, v34, v34 row_shr:2 row_mask:0xf bank_mask:0xf bound_ctrl:0
  v_add_f32_dpp v35, v35, v35 row_shr:2 row_mask:0xf bank_mask:0xf bound_ctrl:0
  v_add_f32_dpp v28, v28, v28 row_shr:4 row_mask:0xf bank_mask:0xf bound_ctrl:0
  v_add_f32_dpp v29, v29, v29 row_shr:4 row_mask:0xf bank_mask:0xf bound_ctrl:0
  v_add_f32_dpp v30, v30, v30 row_shr:4 row_mask:0xf bank_mask:0xf bound_ctrl:0
  v_add_f32_dpp v31, v31, v31 row_shr:4 row_mask:0xf bank_mask:0xf bound_ctrl:0
  v_add_f32_dpp v32, v32, v32 row_shr:4 row_mask:0xf bank_mask:0xf bound_ctrl:0
  v_add_f32_dpp v33, v33, v33 row_shr:4 row_mask:0xf bank_mask:0xf bound_ctrl:0
  v_add_f32_dpp v34, v34, v34 row_shr:4 row_mask:0xf bank_mask:0xf bound_ctrl:0
  v_add_f32_dpp v35, v35, v35 row_shr:4 row_mask:0xf bank_mask:0xf bound_ctrl:0
  v_add_f32_dpp v28, v28, v28 row_shr:8 row_mask:0xf bank_mask:0xf bound_ctrl:0
  v_add_f32_dpp v29, v29, v29 row_shr:8 row_mask:0xf bank_mask:0xf bound_ctrl:0
  v_add_f32_dpp v30, v30, v30 row_shr:8 row_mask:0xf bank_mask:0xf bound_ctrl:0
  v_add_f32_dpp v31, v31, v31 row_shr:8 row_mask:0xf bank_mask:0xf bound_ctrl:0
  v_add_f32_dpp v32, v32, v32 row_shr:8 row_mask:0xf bank_mask:0xf bound_ctrl:0
  v_add_f32_dpp v33, v33, v33 row_shr:8 row_mask:0xf bank_mask:0xf bound_ctrl:0
  v_add_f32_dpp v34, v34, v34 row_shr:8 row_mask:0xf bank_mask:0xf bound_ctrl:0
  v_add_f32_dpp v35, v35, v35 row_shr:8 row_mask:0xf bank_mask:0xf bound_ctrl:0
  v_add_f32_dpp v28, v28, v28 row_bcast:15 row_mask:0xa bank_mask:0xf
  v_add_f32_dpp v29, v29, v29 row_bcast:15 row_mask:0xa bank_mask:0xf
  v_add_f32_dpp v30, v30, v30 row_bcast:15 row_mask:0xa bank_mask:0xf
  v_add_f32_dpp v31, v31, v31 row_bcast:15 row_mask:0xa bank_mask:0xf
  v_add_f32_dpp v32, v32, v32 row_bcast:15 row_mask:0xa bank_mask:0xf
  v_add_f32_dpp v33, v33, v33 row_bcast:15 row_mask:0xa bank_mask:0xf
  v_add_f32_dpp v34, v34, v34 row_bcast:15 row_mask:0xa bank_mask:0xf
  v_add_f32_dpp v35, v35, v35 row_bcast:15 row_mask:0xa bank_mask:0xf
  v_add_f32_dpp v28, v28, v28 row_bcast:31 row_mask:0xc bank_mask:0xf
  v_add_f32_dpp v29, v29, v29 row_bcast:31 row_mask:0xc bank_mask:0xf
  v_add_f32_dpp v30, v30, v30 row_bcast:31 row_mask:0xc bank_mask:0xf
  v_add_f32_dpp v31, v31, v31 row_bcast:31 row_mask:0xc bank_mask:0xf
  v_add_f32_dpp v32, v32, v32 row_bcast:31 row_mask:0xc bank_mask:0xf
  v_add_f32_dpp v33, v33, v33 row_bcast:31 row_mask:0xc bank_mask:0xf
  v_add_f32_dpp v34, v34, v34 row_bcast:31 row_mask:0xc bank_mask:0xf
  v_add_f32_dpp v35, v35, v35 row_bcast:31 row_mask:0xc bank_mask:0xf
  s_lshl_b32 s9, s8, 5
  v_mov_b32 v37, s9
  s_mov_b32 exec_lo, 0
  s_mov_b32 exec_hi, 0x80000000
  ds_write_b128 v37, v[28:31] offset:0
  ds_write_b128 v37, v[32:35] offset:16
  s_mov_b64 exec, -1
  s_waitcnt lgkmcnt(0)
  s_barrier
  v_and_b32 v37, 7, v1
  v_lshlrev_b32 v37, 2, v37
  ds_read_b32 v28, v37 offset:0
  ds_read_b32 v29, v37 offset:32
  ds_read_b32 v30, v37 offset:64
  ds_read_b32 v31, v37 offset:96
  ds_read_b32 v32, v37 offset:128
  s_waitcnt lgkmcnt(0)
  v_add_f32 v36, v28, v29
  v_add_f32 v36, v36, v30
  v_add_f32 v36, v36, v31
  v_add_f32 v36, v36, v32
  v_mul_f32 v36, 0x3acccccd, v36
  s_nop 0
  v_readlane_b32 s16, v36, 0
  v_readlane_b32 s17, v36, 1
  v_readlane_b32 s18, v36, 2
  v_readlane_b32 s19, v36, 3
  v_readlane_b32 s20, v36, 4
  v_readlane_b32 s21, v36, 5
  v_readlane_b32 s22, v36, 6
  v_readlane_b32 s23, v36, 7
  v_subrev_f32 v38, s16, v12
  v_subrev_f32 v39, s16, v13
  v_mul_f32 v28, v38, v38
  v_fmac_f32 v28, v39, v39
  v_subrev_f32 v38, s17, v14
  v_subrev_f32 v39, s17, v15
  v_mul_f32 v29, v38, v38
  v_fmac_f32 v29, v39, v39
  v_subrev_f32 v38, s18, v16
  v_subrev_f32 v39, s18, v17
  v_mul_f32 v30, v38, v38
  v_fmac_f32 v30, v39, v39
  v_subrev_f32 v38, s19, v18
  v_subrev_f32 v39, s19, v19
  v_mul_f32 v31, v38, v38
  v_fmac_f32 v31, v39, v39
  v_subrev_f32 v38, s20, v20
  v_subrev_f32 v39, s20, v21
  v_mul_f32 v32, v38, v38
  v_fmac_f32 v32, v39, v39
  v_subrev_f32 v38, s21, v22
  v_subrev_f32 v39, s21, v23
  v_mul_f32 v33, v38, v38
  v_fmac_f32 v33, v39, v39
  v_subrev_f32 v38, s22, v24
  v_subrev_f32 v39, s22, v25
  v_mul_f32 v34, v38, v38
  v_fmac_f32 v34, v39, v39
  v_subrev_f32 v38, s23, v26
  v_subrev_f32 v39, s23, v27
  v_mul_f32 v35, v38, v38
  v_fmac_f32 v35, v39, v39
  v_add_f32_dpp v28, v28, v28 row_shr:1 row_mask:0xf bank_mask:0xf bound_ctrl:0
  v_add_f32_dpp v29, v29, v29 row_shr:1 row_mask:0xf bank_mask:0xf bound_ctrl:0
  v_add_f32_dpp v30, v30, v30 row_shr:1 row_mask:0xf bank_mask:0xf bound_ctrl:0
  v_add_f32_dpp v31, v31, v31 row_shr:1 row_mask:0xf bank_mask:0xf bound_ctrl:0
  v_add_f32_dpp v32, v32, v32 row_shr:1 row_mask:0xf bank_mask:0xf bound_ctrl:0
  v_add_f32_dpp v33, v33, v33 row_shr:1 row_mask:0xf bank_mask:0xf bound_ctrl:0
  v_add_f32_dpp v34, v34, v34 row_shr:1 row_mask:0xf bank_mask:0xf bound_ctrl:0
  v_add_f32_dpp v35, v35, v35 row_shr:1 row_mask:0xf bank_mask:0xf bound_ctrl:0
  v_add_f32_dpp v28, v28, v28 row_shr:2 row_mask:0xf bank_mask:0xf bound_ctrl:0
  v_add_f32_dpp v29, v29, v29 row_shr:2 row_mask:0xf bank_mask:0xf bound_ctrl:0
  v_add_f32_dpp v30, v30, v30 row_shr:2 row_mask:0xf bank_mask:0xf bound_ctrl:0
  v_add_f32_dpp v31, v31, v31 row_shr:2 row_mask:0xf bank_mask:0xf bound_ctrl:0
  v_add_f32_dpp v32, v32, v32 row_shr:2 row_mask:0xf bank_mask:0xf bound_ctrl:0
  v_add_f32_dpp v33, v33, v33 row_shr:2 row_mask:0xf bank_mask:0xf bound_ctrl:0
  v_add_f32_dpp v34, v34, v34 row_shr:2 row_mask:0xf bank_mask:0xf bound_ctrl:0
  v_add_f32_dpp v35, v35, v35 row_shr:2 row_mask:0xf bank_mask:0xf bound_ctrl:0
  v_add_f32_dpp v28, v28, v28 row_shr:4 row_mask:0xf bank_mask:0xf bound_ctrl:0
  v_add_f32_dpp v29, v29, v29 row_shr:4 row_mask:0xf bank_mask:0xf bound_ctrl:0
  v_add_f32_dpp v30, v30, v30 row_shr:4 row_mask:0xf bank_mask:0xf bound_ctrl:0
  v_add_f32_dpp v31, v31, v31 row_shr:4 row_mask:0xf bank_mask:0xf bound_ctrl:0
  v_add_f32_dpp v32, v32, v32 row_shr:4 row_mask:0xf bank_mask:0xf bound_ctrl:0
  v_add_f32_dpp v33, v33, v33 row_shr:4 row_mask:0xf bank_mask:0xf bound_ctrl:0
  v_add_f32_dpp v34, v34, v34 row_shr:4 row_mask:0xf bank_mask:0xf bound_ctrl:0
  v_add_f32_dpp v35, v35, v35 row_shr:4 row_mask:0xf bank_mask:0xf bound_ctrl:0
  v_add_f32_dpp v28, v28, v28 row_shr:8 row_mask:0xf bank_mask:0xf bound_ctrl:0
  v_add_f32_dpp v29, v29, v29 row_shr:8 row_mask:0xf bank_mask:0xf bound_ctrl:0
  v_add_f32_dpp v30, v30, v30 row_shr:8 row_mask:0xf bank_mask:0xf bound_ctrl:0
  v_add_f32_dpp v31, v31, v31 row_shr:8 row_mask:0xf bank_mask:0xf bound_ctrl:0
  v_add_f32_dpp v32, v32, v32 row_shr:8 row_mask:0xf bank_mask:0xf bound_ctrl:0
  v_add_f32_dpp v33, v33, v33 row_shr:8 row_mask:0xf bank_mask:0xf bound_ctrl:0
  v_add_f32_dpp v34, v34, v34 row_shr:8 row_mask:0xf bank_mask:0xf bound_ctrl:0
  v_add_f32_dpp v35, v35, v35 row_shr:8 row_mask:0xf bank_mask:0xf bound_ctrl:0
  v_add_f32_dpp v28, v28, v28 row_bcast:15 row_mask:0xa bank_mask:0xf
  v_add_f32_dpp v29, v29, v29 row_bcast:15 row_mask:0xa bank_mask:0xf
  v_add_f32_dpp v30, v30, v30 row_bcast:15 row_mask:0xa bank_mask:0xf
  v_add_f32_dpp v31, v31, v31 row_bcast:15 row_mask:0xa bank_mask:0xf
  v_add_f32_dpp v32, v32, v32 row_bcast:15 row_mask:0xa bank_mask:0xf
  v_add_f32_dpp v33, v33, v33 row_bcast:15 row_mask:0xa bank_mask:0xf
  v_add_f32_dpp v34, v34, v34 row_bcast:15 row_mask:0xa bank_mask:0xf
  v_add_f32_dpp v35, v35, v35 row_bcast:15 row_mask:0xa bank_mask:0xf
  v_add_f32_dpp v28, v28, v28 row_bcast:31 row_mask:0xc bank_mask:0xf
  v_add_f32_dpp v29, v29, v29 row_bcast:31 row_mask:0xc bank_mask:0xf
  v_add_f32_dpp v30, v30, v30 row_bcast:31 row_mask:0xc bank_mask:0xf
  v_add_f32_dpp v31, v31, v31 row_bcast:31 row_mask:0xc bank_mask:0xf
  v_add_f32_dpp v32, v32, v32 row_bcast:31 row_mask:0xc bank_mask:0xf
  v_add_f32_dpp v33, v33, v33 row_bcast:31 row_mask:0xc bank_mask:0xf
  v_add_f32_dpp v34, v34, v34 row_bcast:31 row_mask:0xc bank_mask:0xf
  v_add_f32_dpp v35, v35, v35 row_bcast:31 row_mask:0xc bank_mask:0xf
  s_lshl_b32 s9, s8, 5
  v_mov_b32 v37, s9
  s_mov_b32 exec_lo, 0
  s_mov_b32 exec_hi, 0x80000000
  ds_write_b128 v37, v[28:31] offset:256
  ds_write_b128 v37, v[32:35] offset:272
  s_mov_b64 exec, -1
  s_waitcnt lgkmcnt(0)
  s_barrier
  v_and_b32 v37, 7, v1
  v_lshlrev_b32 v37, 2, v37
  ds_read_b32 v28, v37 offset:256
  ds_read_b32 v29, v37 offset:288
  ds_read_b32 v30, v37 offset:320
  ds_read_b32 v31, v37 offset:352
  ds_read_b32 v32, v37 offset:384
  s_waitcnt lgkmcnt(0)
  v_add_f32 v40, v28, v29
  v_add_f32 v40, v40, v30
  v_add_f32 v40, v40, v31
  v_add_f32 v40, v40, v32
  v_mul_f32 v40, 0x3acccccd, v40
  v_cvt_pk_bf16_f32 v36, v36, v36
  v_lshlrev_b32 v36, 16, v36
  v_cvt_pk_bf16_f32 v40, v40, v40
  v_lshlrev_b32 v40, 16, v40
  v_add_f32 v40, 0x3727c5ac, v40
  v_cvt_pk_bf16_f32 v40, v40, v40
  v_lshlrev_b32 v40, 16, v40
  v_sqrt_f32 v40, v40
  s_nop 0
  v_cvt_pk_bf16_f32 v40, v40, v40
  v_lshlrev_b32 v40, 16, v40
  v_rcp_f32 v41, v40
  v_readlane_b32 s24, v36, 0
  v_readlane_b32 s25, v36, 1
  v_readlane_b32 s26, v36, 2
  v_readlane_b32 s27, v36, 3
  v_readlane_b32 s28, v36, 4
  v_readlane_b32 s29, v36, 5
  v_readlane_b32 s30, v36, 6
  v_readlane_b32 s31, v36, 7
  v_readlane_b32 s32, v40, 0
  v_readlane_b32 s33, v40, 1
  v_readlane_b32 s34, v40, 2
  v_readlane_b32 s35, v40, 3
  v_readlane_b32 s36, v40, 4
  v_readlane_b32 s37, v40, 5
  v_readlane_b32 s38, v40, 6
  v_readlane_b32 s39, v40, 7
  v_readlane_b32 s40, v41, 0
  v_readlane_b32 s41, v41, 1
  v_readlane_b32 s42, v41, 2
  v_readlane_b32 s43, v41, 3
  v_readlane_b32 s44, v41, 4
  v_readlane_b32 s45, v41, 5
  v_readlane_b32 s46, v41, 6
  v_readlane_b32 s47, v41, 7
  v_subrev_f32 v12, s24, v12
  v_subrev_f32 v13, s24, v13
  v_cvt_pk_bf16_f32 v36, v12, v13
  v_lshlrev_b32 v12, 16, v36
  v_and_b32 v13, 0xffff0000, v36
  v_mul_f32 v37, s40, v12
  v_mul_f32 v38, s40, v13
  v_fma_f32 v39, -v37, s32, v12
  v_fma_f32 v40, -v38, s32, v13
  v_fmac_f32 v37, s40, v39
  v_fmac_f32 v38, s40, v40
  v_cvt_pk_bf16_f32 v36, v37, v38
  v_lshlrev_b32 v12, 16, v36
  v_and_b32 v13, 0xffff0000, v36
  v_subrev_f32 v14, s25, v14
  v_subrev_f32 v15, s25, v15
  v_cvt_pk_bf16_f32 v36, v14, v15
  v_lshlrev_b32 v14, 16, v36
  v_and_b32 v15, 0xffff0000, v36
  v_mul_f32 v37, s41, v14
  v_mul_f32 v38, s41, v15
  v_fma_f32 v39, -v37, s33, v14
  v_fma_f32 v40, -v38, s33, v15
  v_fmac_f32 v37, s41, v39
  v_fmac_f32 v38, s41, v40
  v_cvt_pk_bf16_f32 v36, v37, v38
  v_lshlrev_b32 v14, 16, v36
  v_and_b32 v15, 0xffff0000, v36
  v_subrev_f32 v16, s26, v16
  v_subrev_f32 v17, s26, v17
  v_cvt_pk_bf16_f32 v36, v16, v17
  v_lshlrev_b32 v16, 16, v36
  v_and_b32 v17, 0xffff0000, v36
  v_mul_f32 v37, s42, v16
  v_mul_f32 v38, s42, v17
  v_fma_f32 v39, -v37, s34, v16
  v_fma_f32 v40, -v38, s34, v17
  v_fmac_f32 v37, s42, v39
  v_fmac_f32 v38, s42, v40
  v_cvt_pk_bf16_f32 v36, v37, v38
  v_lshlrev_b32 v16, 16, v36
  v_and_b32 v17, 0xffff0000, v36
  v_subrev_f32 v18, s27, v18
  v_subrev_f32 v19, s27, v19
  v_cvt_pk_bf16_f32 v36, v18, v19
  v_lshlrev_b32 v18, 16, v36
  v_and_b32 v19, 0xffff0000, v36
  v_mul_f32 v37, s43, v18
  v_mul_f32 v38, s43, v19
  v_fma_f32 v39, -v37, s35, v18
  v_fma_f32 v40, -v38, s35, v19
  v_fmac_f32 v37, s43, v39
  v_fmac_f32 v38, s43, v40
  v_cvt_pk_bf16_f32 v36, v37, v38
  v_lshlrev_b32 v18, 16, v36
  v_and_b32 v19, 0xffff0000, v36
  v_subrev_f32 v20, s28, v20
  v_subrev_f32 v21, s28, v21
  v_cvt_pk_bf16_f32 v36, v20, v21
  v_lshlrev_b32 v20, 16, v36
  v_and_b32 v21, 0xffff0000, v36
  v_mul_f32 v37, s44, v20
  v_mul_f32 v38, s44, v21
  v_fma_f32 v39, -v37, s36, v20
  v_fma_f32 v40, -v38, s36, v21
  v_fmac_f32 v37, s44, v39
  v_fmac_f32 v38, s44, v40
  v_cvt_pk_bf16_f32 v36, v37, v38
  v_lshlrev_b32 v20, 16, v36
  v_and_b32 v21, 0xffff0000, v36
  v_subrev_f32 v22, s29, v22
  v_subrev_f32 v23, s29, v23
  v_cvt_pk_bf16_f32 v36, v22, v23
  v_lshlrev_b32 v22, 16, v36
  v_and_b32 v23, 0xffff0000, v36
  v_mul_f32 v37, s45, v22
  v_mul_f32 v38, s45, v23
  v_fma_f32 v39, -v37, s37, v22
  v_fma_f32 v40, -v38, s37, v23
  v_fmac_f32 v37, s45, v39
  v_fmac_f32 v38, s45, v40
  v_cvt_pk_bf16_f32 v36, v37, v38
  v_lshlrev_b32 v22, 16, v36
  v_and_b32 v23, 0xffff0000, v36
  v_subrev_f32 v24, s30, v24
  v_subrev_f32 v25, s30, v25
  v_cvt_pk_bf16_f32 v36, v24, v25
  v_lshlrev_b32 v24, 16, v36
  v_and_b32 v25, 0xffff0000, v36
  v_mul_f32 v37, s46, v24
  v_mul_f32 v38, s46, v25
  v_fma_f32 v39, -v37, s38, v24
  v_fma_f32 v40, -v38, s38, v25
  v_fmac_f32 v37, s46, v39
  v_fmac_f32 v38, s46, v40
  v_cvt_pk_bf16_f32 v36, v37, v38
  v_lshlrev_b32 v24, 16, v36
  v_and_b32 v25, 0xffff0000, v36
  v_subrev_f32 v26, s31, v26
  v_subrev_f32 v27, s31, v27
  v_cvt_pk_bf16_f32 v36, v26, v27
  v_lshlrev_b32 v26, 16, v36
  v_and_b32 v27, 0xffff0000, v36
  v_mul_f32 v37, s47, v26
  v_mul_f32 v38, s47, v27
  v_fma_f32 v39, -v37, s39, v26
  v_fma_f32 v40, -v38, s39, v27
  v_fmac_f32 v37, s47, v39
  v_fmac_f32 v38, s47, v40
  v_cvt_pk_bf16_f32 v36, v37, v38
  v_lshlrev_b32 v26, 16, v36
  v_and_b32 v27, 0xffff0000, v36
  v_lshlrev_b32 v53, 16, v52
  v_and_b32 v54, 0xffff0000, v52
  v_lshlrev_b32 v36, 16, v64
  v_and_b32 v37, 0xffff0000, v64
  v_add_f32 v36, v36, v12
  v_add_f32 v37, v37, v13
  v_cvt_pk_bf16_f32 v4, v36, v37
  v_mul_f32 v28, v53, v12
  v_fmac_f32 v28, v54, v13
  v_cvt_pk_bf16_f32 v72, v12, v13
  v_lshlrev_b32 v36, 16, v65
  v_and_b32 v37, 0xffff0000, v65
  v_add_f32 v36, v36, v14
  v_add_f32 v37, v37, v15
  v_cvt_pk_bf16_f32 v5, v36, v37
  v_mul_f32 v29, v53, v14
  v_fmac_f32 v29, v54, v15
  v_cvt_pk_bf16_f32 v73, v14, v15
  v_lshlrev_b32 v36, 16, v66
  v_and_b32 v37, 0xffff0000, v66
  v_add_f32 v36, v36, v16
  v_add_f32 v37, v37, v17
  v_cvt_pk_bf16_f32 v6, v36, v37
  v_mul_f32 v30, v53, v16
  v_fmac_f32 v30, v54, v17
  v_cvt_pk_bf16_f32 v74, v16, v17
  v_lshlrev_b32 v36, 16, v67
  v_and_b32 v37, 0xffff0000, v67
  v_add_f32 v36, v36, v18
  v_add_f32 v37, v37, v19
  v_cvt_pk_bf16_f32 v7, v36, v37
  v_mul_f32 v31, v53, v18
  v_fmac_f32 v31, v54, v19
  v_cvt_pk_bf16_f32 v75, v18, v19
  v_lshlrev_b32 v36, 16, v68
  v_and_b32 v37, 0xffff0000, v68
  v_add_f32 v36, v36, v20
  v_add_f32 v37, v37, v21
  v_cvt_pk_bf16_f32 v8, v36, v37
  v_mul_f32 v32, v53, v20
  v_fmac_f32 v32, v54, v21
  v_cvt_pk_bf16_f32 v76, v20, v21
  v_lshlrev_b32 v36, 16, v69
  v_and_b32 v37, 0xffff0000, v69
  v_add_f32 v36, v36, v22
  v_add_f32 v37, v37, v23
  v_cvt_pk_bf16_f32 v9, v36, v37
  v_mul_f32 v33, v53, v22
  v_fmac_f32 v33, v54, v23
  v_cvt_pk_bf16_f32 v77, v22, v23
  v_lshlrev_b32 v36, 16, v70
  v_and_b32 v37, 0xffff0000, v70
  v_add_f32 v36, v36, v24
  v_add_f32 v37, v37, v25
  v_cvt_pk_bf16_f32 v10, v36, v37
  v_mul_f32 v34, v53, v24
  v_fmac_f32 v34, v54, v25
  v_cvt_pk_bf16_f32 v78, v24, v25
  v_lshlrev_b32 v36, 16, v71
  v_and_b32 v37, 0xffff0000, v71
  v_add_f32 v36, v36, v26
  v_add_f32 v37, v37, v27
  v_cvt_pk_bf16_f32 v11, v36, v37
  v_mul_f32 v35, v53, v26
  v_fmac_f32 v35, v54, v27
  v_cvt_pk_bf16_f32 v79, v26, v27
  v_add_f32_dpp v28, v28, v28 row_shr:1 row_mask:0xf bank_mask:0xf bound_ctrl:0
  v_add_f32_dpp v29, v29, v29 row_shr:1 row_mask:0xf bank_mask:0xf bound_ctrl:0
  v_add_f32_dpp v30, v30, v30 row_shr:1 row_mask:0xf bank_mask:0xf bound_ctrl:0
  v_add_f32_dpp v31, v31, v31 row_shr:1 row_mask:0xf bank_mask:0xf bound_ctrl:0
  v_add_f32_dpp v32, v32, v32 row_shr:1 row_mask:0xf bank_mask:0xf bound_ctrl:0
  v_add_f32_dpp v33, v33, v33 row_shr:1 row_mask:0xf bank_mask:0xf bound_ctrl:0
  v_add_f32_dpp v34, v34, v34 row_shr:1 row_mask:0xf bank_mask:0xf bound_ctrl:0
  v_add_f32_dpp v35, v35, v35 row_shr:1 row_mask:0xf bank_mask:0xf bound_ctrl:0
  v_add_f32_dpp v28, v28, v28 row_shr:2 row_mask:0xf bank_mask:0xf bound_ctrl:0
  v_add_f32_dpp v29, v29, v29 row_shr:2 row_mask:0xf bank_mask:0xf bound_ctrl:0
  v_add_f32_dpp v30, v30, v30 row_shr:2 row_mask:0xf bank_mask:0xf bound_ctrl:0
  v_add_f32_dpp v31, v31, v31 row_shr:2 row_mask:0xf bank_mask:0xf bound_ctrl:0
  v_add_f32_dpp v32, v32, v32 row_shr:2 row_mask:0xf bank_mask:0xf bound_ctrl:0
  v_add_f32_dpp v33, v33, v33 row_shr:2 row_mask:0xf bank_mask:0xf bound_ctrl:0
  v_add_f32_dpp v34, v34, v34 row_shr:2 row_mask:0xf bank_mask:0xf bound_ctrl:0
  v_add_f32_dpp v35, v35, v35 row_shr:2 row_mask:0xf bank_mask:0xf bound_ctrl:0
  v_add_f32_dpp v28, v28, v28 row_shr:4 row_mask:0xf bank_mask:0xf bound_ctrl:0
  v_add_f32_dpp v29, v29, v29 row_shr:4 row_mask:0xf bank_mask:0xf bound_ctrl:0
  v_add_f32_dpp v30, v30, v30 row_shr:4 row_mask:0xf bank_mask:0xf bound_ctrl:0
  v_add_f32_dpp v31, v31, v31 row_shr:4 row_mask:0xf bank_mask:0xf bound_ctrl:0
  v_add_f32_dpp v32, v32, v32 row_shr:4 row_mask:0xf bank_mask:0xf bound_ctrl:0
  v_add_f32_dpp v33, v33, v33 row_shr:4 row_mask:0xf bank_mask:0xf bound_ctrl:0
  v_add_f32_dpp v34, v34, v34 row_shr:4 row_mask:0xf bank_mask:0xf bound_ctrl:0
  v_add_f32_dpp v35, v35, v35 row_shr:4 row_mask:0xf bank_mask:0xf bound_ctrl:0
  v_add_f32_dpp v28, v28, v28 row_shr:8 row_mask:0xf bank_mask:0xf bound_ctrl:0
  v_add_f32_dpp v29, v29, v29 row_shr:8 row_mask:0xf bank_mask:0xf bound_ctrl:0
  v_add_f32_dpp v30, v30, v30 row_shr:8 row_mask:0xf bank_mask:0xf bound_ctrl:0
  v_add_f32_dpp v31, v31, v31 row_shr:8 row_mask:0xf bank_mask:0xf bound_ctrl:0
  v_add_f32_dpp v32, v32, v32 row_shr:8 row_mask:0xf bank_mask:0xf bound_ctrl:0
  v_add_f32_dpp v33, v33, v33 row_shr:8 row_mask:0xf bank_mask:0xf bound_ctrl:0
  v_add_f32_dpp v34, v34, v34 row_shr:8 row_mask:0xf bank_mask:0xf bound_ctrl:0
  v_add_f32_dpp v35, v35, v35 row_shr:8 row_mask:0xf bank_mask:0xf bound_ctrl:0
  v_add_f32_dpp v28, v28, v28 row_bcast:15 row_mask:0xa bank_mask:0xf
  v_add_f32_dpp v29, v29, v29 row_bcast:15 row_mask:0xa bank_mask:0xf
  v_add_f32_dpp v30, v30, v30 row_bcast:15 row_mask:0xa bank_mask:0xf
  v_add_f32_dpp v31, v31, v31 row_bcast:15 row_mask:0xa bank_mask:0xf
  v_add_f32_dpp v32, v32, v32 row_bcast:15 row_mask:0xa bank_mask:0xf
  v_add_f32_dpp v33, v33, v33 row_bcast:15 row_mask:0xa bank_mask:0xf
  v_add_f32_dpp v34, v34, v34 row_bcast:15 row_mask:0xa bank_mask:0xf
  v_add_f32_dpp v35, v35, v35 row_bcast:15 row_mask:0xa bank_mask:0xf
  v_add_f32_dpp v28, v28, v28 row_bcast:31 row_mask:0xc bank_mask:0xf
  v_add_f32_dpp v29, v29, v29 row_bcast:31 row_mask:0xc bank_mask:0xf
  v_add_f32_dpp v30, v30, v30 row_bcast:31 row_mask:0xc bank_mask:0xf
  v_add_f32_dpp v31, v31, v31 row_bcast:31 row_mask:0xc bank_mask:0xf
  v_add_f32_dpp v32, v32, v32 row_bcast:31 row_mask:0xc bank_mask:0xf
  v_add_f32_dpp v33, v33, v33 row_bcast:31 row_mask:0xc bank_mask:0xf
  v_add_f32_dpp v34, v34, v34 row_bcast:31 row_mask:0xc bank_mask:0xf
  v_add_f32_dpp v35, v35, v35 row_bcast:31 row_mask:0xc bank_mask:0xf
  s_lshl_b32 s9, s8, 5
  v_mov_b32 v37, s9
  s_mov_b32 exec_lo, 0
  s_mov_b32 exec_hi, 0x80000000
  ds_write_b128 v37, v[28:31] offset:512
  ds_write_b128 v37, v[32:35] offset:528
  s_mov_b64 exec, -1
  s_waitcnt lgkmcnt(0)
  s_barrier
  v_and_b32 v37, 7, v1
  v_lshlrev_b32 v37, 2, v37
  ds_read_b32 v28, v37 offset:512
  ds_read_b32 v29, v37 offset:544
  ds_read_b32 v30, v37 offset:576
  ds_read_b32 v31, v37 offset:608
  ds_read_b32 v32, v37 offset:640
  s_waitcnt lgkmcnt(0)
  v_add_f32 v36, v28, v29
  v_add_f32 v36, v36, v30
  v_add_f32 v36, v36, v31
  v_add_f32 v36, v36, v32
  v_cvt_pk_bf16_f32 v36, v36, v36
  v_and_b32 v36, 0xffff, v36
  v_bfe_i32 v37, v36, 15, 1
  v_xor_b32 v38, 0x8000, v36
  v_not_b32 v39, v36
  v_and_b32 v39, 0xffff, v39
  v_cmp_ne_u32 vcc, 0, v37
  s_nop 1
  v_cndmask_b32 v38, v38, v39, vcc
  v_lshlrev_b32 v38, 16, v38
  v_and_b32 v39, 7, v1
  s_lshl_b32 s3, s2, 3
  v_add_u32 v39, s3, v39
  v_sub_u32 v39, 0xffff, v39
  v_or_b32 v38, v38, v39
  s_nop 1
  v_max_u32_dpp v38, v38, v38 row_shr:1 row_mask:0xf bank_mask:0xf bound_ctrl:0
  s_nop 1
  v_max_u32_dpp v38, v38, v38 row_shr:2 row_mask:0xf bank_mask:0xf bound_ctrl:0
  s_nop 1
  v_max_u32_dpp v38, v38, v38 row_shr:4 row_mask:0xf bank_mask:0xf bound_ctrl:0
  s_nop 0
  v_readlane_b32 s16, v38, 7
  s_nop 0
  s_and_b32 s17, s16, 7
  s_xor_b32 s17, s17, 7
  s_add_u32 s18, s6, 0x00540000
  s_addc_u32 s19, s7, 0
  s_add_u32 s20, s6, 0x00541000
  s_addc_u32 s21, s7, 0
  s_mul_i32 s3, s2, 2560
  v_add_u32 v3, s3, v2
  s_cmp_eq_u32 s17, 0
  s_cbranch_scc0 KB_SK0
  global_store_dword v3, v72, s[20:21] sc1
  global_store_dword v3, v64, s[20:21] offset:1280 sc1
  global_store_dword v60, v4, s[12:13] offset:0 sc1
  s_waitcnt vmcnt(0)
  s_branch KB_SJ0
KB_SK0:
  global_store_dword v60, v4, s[12:13] offset:0
KB_SJ0:
  s_cmp_eq_u32 s17, 1
  s_cbranch_scc0 KB_SK1
  global_store_dword v3, v73, s[20:21] sc1
  global_store_dword v3, v65, s[20:21] offset:1280 sc1
  global_store_dword v60, v5, s[12:13] offset:1280 sc1
  s_waitcnt vmcnt(0)
  s_branch KB_SJ1
KB_SK1:
  global_store_dword v60, v5, s[12:13] offset:1280
KB_SJ1:
  s_cmp_eq_u32 s17, 2
  s_cbranch_scc0 KB_SK2
  global_store_dword v3, v74, s[20:21] sc1
  global_store_dword v3, v66, s[20:21] offset:1280 sc1
  global_store_dword v60, v6, s[12:13] offset:2560 sc1
  s_waitcnt vmcnt(0)
  s_branch KB_SJ2
KB_SK2:
  global_store_dword v60, v6, s[12:13] offset:2560
KB_SJ2:
  s_cmp_eq_u32 s17, 3
  s_cbranch_scc0 KB_SK3
  global_store_dword v3, v75, s[20:21] sc1
  global_store_dword v3, v67, s[20:21] offset:1280 sc1
  global_store_dword v60, v7, s[12:13] offset:3840 sc1
  s_waitcnt vmcnt(0)
  s_branch KB_SJ3
KB_SK3:
  global_store_dword v60, v7, s[12:13] offset:3840
KB_SJ3:
  s_cmp_eq_u32 s17, 4
  s_cbranch_scc0 KB_SK4
  global_store_dword v3, v76, s[20:21] sc1
  global_store_dword v3, v68, s[20:21] offset:1280 sc1
  global_store_dword v61, v8, s[12:13] offset:0 sc1
  s_waitcnt vmcnt(0)
  s_branch KB_SJ4
KB_SK4:
  global_store_dword v61, v8, s[12:13] offset:0
KB_SJ4:
  s_cmp_eq_u32 s17, 5
  s_cbranch_scc0 KB_SK5
  global_store_dword v3, v77, s[20:21] sc1
  global_store_dword v3, v69, s[20:21] offset:1280 sc1
  global_store_dword v61, v9, s[12:13] offset:1280 sc1
  s_waitcnt vmcnt(0)
  s_branch KB_SJ5
KB_SK5:
  global_store_dword v61, v9, s[12:13] offset:1280
KB_SJ5:
  s_cmp_eq_u32 s17, 6
  s_cbranch_scc0 KB_SK6
  global_store_dword v3, v78, s[20:21] sc1
  global_store_dword v3, v70, s[20:21] offset:1280 sc1
  global_store_dword v61, v10, s[12:13] offset:2560 sc1
  s_waitcnt vmcnt(0)
  s_branch KB_SJ6
KB_SK6:
  global_store_dword v61, v10, s[12:13] offset:2560
KB_SJ6:
  s_cmp_eq_u32 s17, 7
  s_cbranch_scc0 KB_SK7
  global_store_dword v3, v79, s[20:21] sc1
  global_store_dword v3, v71, s[20:21] offset:1280 sc1
  global_store_dword v61, v11, s[12:13] offset:3840 sc1
  s_waitcnt vmcnt(0)
  s_branch KB_SJ7
KB_SK7:
  global_store_dword v61, v11, s[12:13] offset:3840
KB_SJ7:
  s_barrier
  s_lshl_b32 s3, s2, 2
  v_mov_b32 v3, s3
  v_mov_b32 v4, s16
  v_cmp_eq_u32 vcc, 0, v0
  s_nop 0
  s_and_saveexec_b64 s[30:31], vcc
  s_cbranch_execz KB_END
  global_store_dword v3, v4, s[18:19] sc1
  s_endpgm
KB_FFN:
  s_sub_u32 s2, s2, 256
  s_load_dwordx2 s[6:7], s[0:1], 128
  s_load_dwordx4 s[12:15], s[0:1], 88
  s_load_dwordx2 s[16:17], s[0:1], 104
  s_load_dwordx2 s[4:5], s[0:1], 112
  s_load_dwordx2 s[10:11], s[0:1], 120
  v_lshrrev_b32 v63, 6, v0
  s_nop 0
  v_readfirstlane_b32 s8, v63
  v_and_b32 v1, 63, v0
  s_and_b32 s3, s2, 7
  s_mul_i32 s3, s3, 12
  s_lshr_b32 s9, s2, 3
  s_add_u32 s3, s3, s9
  v_and_b32 v2, 31, v1
  v_lshrrev_b32 v3, 5, v1
  s_lshl_b32 s9, s8, 5
  v_add_u32 v2, s9, v2
  v_mul_u32_u24 v4, 3072, v2
  v_lshl_add_u32 v4, v3, 4, v4
  s_lshl_b32 s9, s3, 5
  v_add_u32 v4, s9, v4
  s_waitcnt lgkmcnt(0)
  s_add_u32 s18, s6, 0x00540000
  s_addc_u32 s19, s7, 0
  s_add_u32 s20, s6, 0x00541000
  s_addc_u32 s21, s7, 0
  global_load_dwordx4 v[16:19], v4, s[12:13]
  global_load_dwordx4 v[32:35], v4, s[14:15]
  v_add_u32 v5, 491520, v4
  global_load_dwordx4 v[20:23], v5, s[12:13]
  global_load_dwordx4 v[36:39], v5, s[14:15]
  v_add_u32 v6, 983040, v4
  global_load_dwordx4 v[24:27], v6, s[12:13]
  global_load_dwordx4 v[40:43], v6, s[14:15]
  v_add_u32 v7, 1474560, v4
  global_load_dwordx4 v[28:31], v7, s[12:13]
  global_load_dwordx4 v[44:47], v7, s[14:15]
  s_mul_i32 s9, s3, 20480
  v_lshlrev_b32 v8, 2, v0
  v_add_u32 v9, s9, v8
  global_load_dword v48, v9, s[16:17] offset:0
  global_load_dword v49, v9, s[16:17] offset:1280
  global_load_dword v50, v9, s[16:17] offset:2560
  v_add_u32 v9, 3840, v9
  global_load_dword v51, v9, s[16:17] offset:0
  global_load_dword v52, v9, s[16:17] offset:1280
  global_load_dword v53, v9, s[16:17] offset:2560
  v_add_u32 v9, 3840, v9
  global_load_dword v54, v9, s[16:17] offset:0
  global_load_dword v55, v9, s[16:17] offset:1280
  global_load_dword v56, v9, s[16:17] offset:2560
  v_add_u32 v9, 3840, v9
  global_load_dword v57, v9, s[16:17] offset:0
  global_load_dword v58, v9, s[16:17] offset:1280
  global_load_dword v59, v9, s[16:17] offset:2560
  v_add_u32 v9, 3840, v9
  global_load_dword v60, v9, s[16:17] offset:0
  global_load_dword v61, v9, s[16:17] offset:1280
  global_load_dword v62, v9, s[16:17] offset:2560
  v_add_u32 v9, 3840, v9
  global_load_dword v63, v9, s[16:17] offset:0
  s_cmp_lg_u32 s8, 0
  s_cbranch_scc1 KB4_KW
  v_lshlrev_b32 v100, 4, v1
  s_mov_b32 s27, 0
  s_sleep 127
KB4_KP:
  global_load_dwordx4 v[104:107], v100, s[18:19] sc1
  s_waitcnt vmcnt(0)
  v_min_u32 v101, v104, v105
  v_min3_u32 v101, v101, v106, v107
  v_cmp_eq_u32 vcc, 0, v101
  s_nop 0
  s_cmp_eq_u64 vcc, 0
  s_cbranch_scc1 KB4_KG
  s_add_u32 s27, s27, 1
  s_cmp_ge_u32 s27, 0x10000
  s_cbranch_scc1 KB4_KG
  s_sleep 4
  s_branch KB4_KP
KB4_KG:
  v_max_u32 v104, v104, v105
  v_max_u32 v106, v106, v107
  v_max_u32 v104, v104, v106
  s_nop 1
  v_max_u32_dpp v104, v104, v104 row_shr:1 row_mask:0xf bank_mask:0xf bound_ctrl:0
  s_nop 1
  v_max_u32_dpp v104, v104, v104 row_shr:2 row_mask:0xf bank_mask:0xf bound_ctrl:0
  s_nop 1
  v_max_u32_dpp v104, v104, v104 row_shr:4 row_mask:0xf bank_mask:0xf bound_ctrl:0
  s_nop 1
  v_max_u32_dpp v104, v104, v104 row_shr:8 row_mask:0xf bank_mask:0xf bound_ctrl:0
  s_nop 1
  v_max_u32_dpp v104, v104, v104 row_bcast:15 row_mask:0xa bank_mask:0xf
  s_nop 1
  v_max_u32_dpp v104, v104, v104 row_bcast:31 row_mask:0xc bank_mask:0xf
  v_mov_b32 v101, 1536
  s_mov_b32 exec_lo, 0
  s_mov_b32 exec_hi, 0x80000000
  ds_write_b32 v101, v104
  s_mov_b64 exec, -1
  s_waitcnt lgkmcnt(0)
KB4_KW:
  s_barrier
  v_mov_b32 v101, 1536
  ds_read_b32 v104, v101
  s_waitcnt lgkmcnt(0)
  v_readfirstlane_b32 s22, v104
  s_nop 0
  s_and_b32 s23, s22, 0xffff
  s_sub_u32 s23, 0xffff, s23
  s_lshr_b32 s24, s23, 3
  s_mul_i32 s24, s24, 2560
  v_lshlrev_b32 v10, 1, v2
  v_add_u32 v10, s24, v10
  global_load_ushort v64, v10, s[20:21] offset:0 sc1
  global_load_ushort v65, v10, s[20:21] offset:320 sc1
  global_load_ushort v66, v10, s[20:21] offset:640 sc1
  global_load_ushort v67, v10, s[20:21] offset:960 sc1
  s_waitcnt vmcnt(0)
  v_mov_b32 v68, 0
  v_mov_b32 v69, 0
  v_mov_b32 v70, 0
  v_mov_b32 v71, 0
  v_mov_b32 v72, 0
  v_mov_b32 v73, 0
  v_mov_b32 v74, 0
  v_mov_b32 v75, 0
  v_mov_b32 v76, 0
  v_mov_b32 v77, 0
  v_mov_b32 v78, 0
  v_mov_b32 v79, 0
  v_mov_b32 v80, 0
  v_mov_b32 v81, 0
  v_mov_b32 v82, 0
  v_mov_b32 v83, 0
  v_lshlrev_b32 v64, 16, v64
  v_lshlrev_b32 v84, 16, v16
  v_and_b32 v85, 0xffff0000, v16
  v_fmac_f32 v68, v64, v84
  v_fmac_f32 v69, v64, v85
  v_lshlrev_b32 v84, 16, v17
  v_and_b32 v85, 0xffff0000, v17
  v_fmac_f32 v70, v64, v84
  v_fmac_f32 v71, v64, v85
  v_lshlrev_b32 v84, 16, v18
  v_and_b32 v85, 0xffff0000, v18
  v_fmac_f32 v72, v64, v84
  v_fmac_f32 v73, v64, v85
  v_lshlrev_b32 v84, 16, v19
  v_and_b32 v85, 0xffff0000, v19
  v_fmac_f32 v74, v64, v84
  v_fmac_f32 v75, v64, v85
  v_lshlrev_b32 v84, 16, v32
  v_and_b32 v85, 0xffff0000, v32
  v_fmac_f32 v76, v64, v84
  v_fmac_f32 v77, v64, v85
  v_lshlrev_b32 v84, 16, v33
  v_and_b32 v85, 0xffff0000, v33
  v_fmac_f32 v78, v64, v84
  v_fmac_f32 v79, v64, v85
  v_lshlrev_b32 v84, 16, v34
  v_and_b32 v85, 0xffff0000, v34
  v_fmac_f32 v80, v64, v84
  v_fmac_f32 v81, v64, v85
  v_lshlrev_b32 v84, 16, v35
  v_and_b32 v85, 0xffff0000, v35
  v_fmac_f32 v82, v64, v84
  v_fmac_f32 v83, v64, v85
  v_lshlrev_b32 v65, 16, v65
  v_lshlrev_b32 v84, 16, v20
  v_and_b32 v85, 0xffff0000, v20
  v_fmac_f32 v68, v65, v84
  v_fmac_f32 v69, v65, v85
  v_lshlrev_b32 v84, 16, v21
  v_and_b32 v85, 0xffff0000, v21
  v_fmac_f32 v70, v65, v84
  v_fmac_f32 v71, v65, v85
  v_lshlrev_b32 v84, 16, v22
  v_and_b32 v85, 0xffff0000, v22
  v_fmac_f32 v72, v65, v84
  v_fmac_f32 v73, v65, v85
  v_lshlrev_b32 v84, 16, v23
  v_and_b32 v85, 0xffff0000, v23
  v_fmac_f32 v74, v65, v84
  v_fmac_f32 v75, v65, v85
  v_lshlrev_b32 v84, 16, v36
  v_and_b32 v85, 0xffff0000, v36
  v_fmac_f32 v76, v65, v84
  v_fmac_f32 v77, v65, v85
  v_lshlrev_b32 v84, 16, v37
  v_and_b32 v85, 0xffff0000, v37
  v_fmac_f32 v78, v65, v84
  v_fmac_f32 v79, v65, v85
  v_lshlrev_b32 v84, 16, v38
  v_and_b32 v85, 0xffff0000, v38
  v_fmac_f32 v80, v65, v84
  v_fmac_f32 v81, v65, v85
  v_lshlrev_b32 v84, 16, v39
  v_and_b32 v85, 0xffff0000, v39
  v_fmac_f32 v82, v65, v84
  v_fmac_f32 v83, v65, v85
  v_lshlrev_b32 v66, 16, v66
  v_lshlrev_b32 v84, 16, v24
  v_and_b32 v85, 0xffff0000, v24
  v_fmac_f32 v68, v66, v84
  v_fmac_f32 v69, v66, v85
  v_lshlrev_b32 v84, 16, v25
  v_and_b32 v85, 0xffff0000, v25
  v_fmac_f32 v70, v66, v84
  v_fmac_f32 v71, v66, v85
  v_lshlrev_b32 v84, 16, v26
  v_and_b32 v85, 0xffff0000, v26
  v_fmac_f32 v72, v66, v84
  v_fmac_f32 v73, v66, v85
  v_lshlrev_b32 v84, 16, v27
  v_and_b32 v85, 0xffff0000, v27
  v_fmac_f32 v74, v66, v84
  v_fmac_f32 v75, v66, v85
  v_lshlrev_b32 v84, 16, v40
  v_and_b32 v85, 0xffff0000, v40
  v_fmac_f32 v76, v66, v84
  v_fmac_f32 v77, v66, v85
  v_lshlrev_b32 v84, 16, v41
  v_and_b32 v85, 0xffff0000, v41
  v_fmac_f32 v78, v66, v84
  v_fmac_f32 v79, v66, v85
  v_lshlrev_b32 v84, 16, v42
  v_and_b32 v85, 0xffff0000, v42
  v_fmac_f32 v80, v66, v84
  v_fmac_f32 v81, v66, v85
  v_lshlrev_b32 v84, 16, v43
  v_and_b32 v85, 0xffff0000, v43
  v_fmac_f32 v82, v66, v84
  v_fmac_f32 v83, v66, v85
  v_lshlrev_b32 v67, 16, v67
  v_lshlrev_b32 v84, 16, v28
  v_and_b32 v85, 0xffff0000, v28
  v_fmac_f32 v68, v67, v84
  v_fmac_f32 v69, v67, v85
  v_lshlrev_b32 v84, 16, v29
  v_and_b32 v85, 0xffff0000, v29
  v_fmac_f32 v70, v67, v84
  v_fmac_f32 v71, v67, v85
  v_lshlrev_b32 v84, 16, v30
  v_and_b32 v85, 0xffff0000, v30
  v_fmac_f32 v72, v67, v84
  v_fmac_f32 v73, v67, v85
  v_lshlrev_b32 v84, 16, v31
  v_and_b32 v85, 0xffff0000, v31
  v_fmac_f32 v74, v67, v84
  v_fmac_f32 v75, v67, v85
  v_lshlrev_b32 v84, 16, v44
  v_and_b32 v85, 0xffff0000, v44
  v_fmac_f32 v76, v67, v84
  v_fmac_f32 v77, v67, v85
  v_lshlrev_b32 v84, 16, v45
  v_and_b32 v85, 0xffff0000, v45
  v_fmac_f32 v78, v67, v84
  v_fmac_f32 v79, v67, v85
  v_lshlrev_b32 v84, 16, v46
  v_and_b32 v85, 0xffff0000, v46
  v_fmac_f32 v80, v67, v84
  v_fmac_f32 v81, v67, v85
  v_lshlrev_b32 v84, 16, v47
  v_and_b32 v85, 0xffff0000, v47
  v_fmac_f32 v82, v67, v84
  v_fmac_f32 v83, v67, v85
  v_add_f32_dpp v68, v68, v68 row_shr:1 row_mask:0xf bank_mask:0xf bound_ctrl:0
  v_add_f32_dpp v69, v69, v69 row_shr:1 row_mask:0xf bank_mask:0xf bound_ctrl:0
  v_add_f32_dpp v70, v70, v70 row_shr:1 row_mask:0xf bank_mask:0xf bound_ctrl:0
  v_add_f32_dpp v71, v71, v71 row_shr:1 row_mask:0xf bank_mask:0xf bound_ctrl:0
  v_add_f32_dpp v72, v72, v72 row_shr:1 row_mask:0xf bank_mask:0xf bound_ctrl:0
  v_add_f32_dpp v73, v73, v73 row_shr:1 row_mask:0xf bank_mask:0xf bound_ctrl:0
  v_add_f32_dpp v74, v74, v74 row_shr:1 row_mask:0xf bank_mask:0xf bound_ctrl:0
  v_add_f32_dpp v75, v75, v75 row_shr:1 row_mask:0xf bank_mask:0xf bound_ctrl:0
  v_add_f32_dpp v76, v76, v76 row_shr:1 row_mask:0xf bank_mask:0xf bound_ctrl:0
  v_add_f32_dpp v77, v77, v77 row_shr:1 row_mask:0xf bank_mask:0xf bound_ctrl:0
  v_add_f32_dpp v78, v78, v78 row_shr:1 row_mask:0xf bank_mask:0xf bound_ctrl:0
  v_add_f32_dpp v79, v79, v79 row_shr:1 row_mask:0xf bank_mask:0xf bound_ctrl:0
  v_add_f32_dpp v80, v80, v80 row_shr:1 row_mask:0xf bank_mask:0xf bound_ctrl:0
  v_add_f32_dpp v81, v81, v81 row_shr:1 row_mask:0xf bank_mask:0xf bound_ctrl:0
  v_add_f32_dpp v82, v82, v82 row_shr:1 row_mask:0xf bank_mask:0xf bound_ctrl:0
  v_add_f32_dpp v83, v83, v83 row_shr:1 row_mask:0xf bank_mask:0xf bound_ctrl:0
  v_add_f32_dpp v68, v68, v68 row_shr:2 row_mask:0xf bank_mask:0xf bound_ctrl:0
  v_add_f32_dpp v69, v69, v69 row_shr:2 row_mask:0xf bank_mask:0xf bound_ctrl:0
  v_add_f32_dpp v70, v70, v70 row_shr:2 row_mask:0xf bank_mask:0xf bound_ctrl:0
  v_add_f32_dpp v71, v71, v71 row_shr:2 row_mask:0xf bank_mask:0xf bound_ctrl:0
  v_add_f32_dpp v72, v72, v72 row_shr:2 row_mask:0xf bank_mask:0xf bound_ctrl:0
  v_add_f32_dpp v73, v73, v73 row_shr:2 row_mask:0xf bank_mask:0xf bound_ctrl:0
  v_add_f32_dpp v74, v74, v74 row_shr:2 row_mask:0xf bank_mask:0xf bound_ctrl:0
  v_add_f32_dpp v75, v75, v75 row_shr:2 row_mask:0xf bank_mask:0xf bound_ctrl:0
  v_add_f32_dpp v76, v76, v76 row_shr:2 row_mask:0xf bank_mask:0xf bound_ctrl:0
  v_add_f32_dpp v77, v77, v77 row_shr:2 row_mask:0xf bank_mask:0xf bound_ctrl:0
  v_add_f32_dpp v78, v78, v78 row_shr:2 row_mask:0xf bank_mask:0xf bound_ctrl:0
  v_add_f32_dpp v79, v79, v79 row_shr:2 row_mask:0xf bank_mask:0xf bound_ctrl:0
  v_add_f32_dpp v80, v80, v80 row_shr:2 row_mask:0xf bank_mask:0xf bound_ctrl:0
  v_add_f32_dpp v81, v81, v81 row_shr:2 row_mask:0xf bank_mask:0xf bound_ctrl:0
  v_add_f32_dpp v82, v82, v82 row_shr:2 row_mask:0xf bank_mask:0xf bound_ctrl:0
  v_add_f32_dpp v83, v83, v83 row_shr:2 row_mask:0xf bank_mask:0xf bound_ctrl:0
  v_add_f32_dpp v68, v68, v68 row_shr:4 row_mask:0xf bank_mask:0xf bound_ctrl:0
  v_add_f32_dpp v69, v69, v69 row_shr:4 row_mask:0xf bank_mask:0xf bound_ctrl:0
  v_add_f32_dpp v70, v70, v70 row_shr:4 row_mask:0xf bank_mask:0xf bound_ctrl:0
  v_add_f32_dpp v71, v71, v71 row_shr:4 row_mask:0xf bank_mask:0xf bound_ctrl:0
  v_add_f32_dpp v72, v72, v72 row_shr:4 row_mask:0xf bank_mask:0xf bound_ctrl:0
  v_add_f32_dpp v73, v73, v73 row_shr:4 row_mask:0xf bank_mask:0xf bound_ctrl:0
  v_add_f32_dpp v74, v74, v74 row_shr:4 row_mask:0xf bank_mask:0xf bound_ctrl:0
  v_add_f32_dpp v75, v75, v75 row_shr:4 row_mask:0xf bank_mask:0xf bound_ctrl:0
  v_add_f32_dpp v76, v76, v76 row_shr:4 row_mask:0xf bank_mask:0xf bound_ctrl:0
  v_add_f32_dpp v77, v77, v77 row_shr:4 row_mask:0xf bank_mask:0xf bound_ctrl:0
  v_add_f32_dpp v78, v78, v78 row_shr:4 row_mask:0xf bank_mask:0xf bound_ctrl:0
  v_add_f32_dpp v79, v79, v79 row_shr:4 row_mask:0xf bank_mask:0xf bound_ctrl:0
  v_add_f32_dpp v80, v80, v80 row_shr:4 row_mask:0xf bank_mask:0xf bound_ctrl:0
  v_add_f32_dpp v81, v81, v81 row_shr:4 row_mask:0xf bank_mask:0xf bound_ctrl:0
  v_add_f32_dpp v82, v82, v82 row_shr:4 row_mask:0xf bank_mask:0xf bound_ctrl:0
  v_add_f32_dpp v83, v83, v83 row_shr:4 row_mask:0xf bank_mask:0xf bound_ctrl:0
  v_add_f32_dpp v68, v68, v68 row_shr:8 row_mask:0xf bank_mask:0xf bound_ctrl:0
  v_add_f32_dpp v69, v69, v69 row_shr:8 row_mask:0xf bank_mask:0xf bound_ctrl:0
  v_add_f32_dpp v70, v70, v70 row_shr:8 row_mask:0xf bank_mask:0xf bound_ctrl:0
  v_add_f32_dpp v71, v71, v71 row_shr:8 row_mask:0xf bank_mask:0xf bound_ctrl:0
  v_add_f32_dpp v72, v72, v72 row_shr:8 row_mask:0xf bank_mask:0xf bound_ctrl:0
  v_add_f32_dpp v73, v73, v73 row_shr:8 row_mask:0xf bank_mask:0xf bound_ctrl:0
  v_add_f32_dpp v74, v74, v74 row_shr:8 row_mask:0xf bank_mask:0xf bound_ctrl:0
  v_add_f32_dpp v75, v75, v75 row_shr:8 row_mask:0xf bank_mask:0xf bound_ctrl:0
  v_add_f32_dpp v76, v76, v76 row_shr:8 row_mask:0xf bank_mask:0xf bound_ctrl:0
  v_add_f32_dpp v77, v77, v77 row_shr:8 row_mask:0xf bank_mask:0xf bound_ctrl:0
  v_add_f32_dpp v78, v78, v78 row_shr:8 row_mask:0xf bank_mask:0xf bound_ctrl:0
  v_add_f32_dpp v79, v79, v79 row_shr:8 row_mask:0xf bank_mask:0xf bound_ctrl:0
  v_add_f32_dpp v80, v80, v80 row_shr:8 row_mask:0xf bank_mask:0xf bound_ctrl:0
  v_add_f32_dpp v81, v81, v81 row_shr:8 row_mask:0xf bank_mask:0xf bound_ctrl:0
  v_add_f32_dpp v82, v82, v82 row_shr:8 row_mask:0xf bank_mask:0xf bound_ctrl:0
  v_add_f32_dpp v83, v83, v83 row_shr:8 row_mask:0xf bank_mask:0xf bound_ctrl:0
  v_add_f32_dpp v68, v68, v68 row_bcast:15 row_mask:0xa bank_mask:0xf
  v_add_f32_dpp v69, v69, v69 row_bcast:15 row_mask:0xa bank_mask:0xf
  v_add_f32_dpp v70, v70, v70 row_bcast:15 row_mask:0xa bank_mask:0xf
  v_add_f32_dpp v71, v71, v71 row_bcast:15 row_mask:0xa bank_mask:0xf
  v_add_f32_dpp v72, v72, v72 row_bcast:15 row_mask:0xa bank_mask:0xf
  v_add_f32_dpp v73, v73, v73 row_bcast:15 row_mask:0xa bank_mask:0xf
  v_add_f32_dpp v74, v74, v74 row_bcast:15 row_mask:0xa bank_mask:0xf
  v_add_f32_dpp v75, v75, v75 row_bcast:15 row_mask:0xa bank_mask:0xf
  v_add_f32_dpp v76, v76, v76 row_bcast:15 row_mask:0xa bank_mask:0xf
  v_add_f32_dpp v77, v77, v77 row_bcast:15 row_mask:0xa bank_mask:0xf
  v_add_f32_dpp v78, v78, v78 row_bcast:15 row_mask:0xa bank_mask:0xf
  v_add_f32_dpp v79, v79, v79 row_bcast:15 row_mask:0xa bank_mask:0xf
  v_add_f32_dpp v80, v80, v80 row_bcast:15 row_mask:0xa bank_mask:0xf
  v_add_f32_dpp v81, v81, v81 row_bcast:15 row_mask:0xa bank_mask:0xf
  v_add_f32_dpp v82, v82, v82 row_bcast:15 row_mask:0xa bank_mask:0xf
  v_add_f32_dpp v83, v83, v83 row_bcast:15 row_mask:0xa bank_mask:0xf
  s_lshl_b32 s9, s8, 7
  v_lshlrev_b32 v86, 6, v3
  v_add_u32 v86, s9, v86
  s_mov_b32 exec_lo, 0x80000000
  s_mov_b32 exec_hi, 0x80000000
  ds_write_b128 v86, v[68:71] offset:0
  ds_write_b128 v86, v[72:75] offset:16
  ds_write_b128 v86, v[76:79] offset:32
  ds_write_b128 v86, v[80:83] offset:48
  s_mov_b64 exec, -1
  s_waitcnt lgkmcnt(0)
  s_barrier
  v_and_b32 v86, 15, v1
  v_lshrrev_b32 v87, 3, v86
  v_and_b32 v86, 7, v86
  v_lshlrev_b32 v86, 2, v86
  v_lshl_add_u32 v86, v87, 6, v86
  ds_read_b32 v68, v86 offset:0
  ds_read_b32 v76, v86 offset:32
  ds_read_b32 v69, v86 offset:128
  ds_read_b32 v77, v86 offset:160
  ds_read_b32 v70, v86 offset:256
  ds_read_b32 v78, v86 offset:288
  ds_read_b32 v71, v86 offset:384
  ds_read_b32 v79, v86 offset:416
  ds_read_b32 v72, v86 offset:512
  ds_read_b32 v80, v86 offset:544
  s_waitcnt lgkmcnt(0)
  v_add_f32 v68, v68, v69
  v_add_f32 v76, v76, v77
  v_add_f32 v68, v68, v70
  v_add_f32 v76, v76, v78
  v_add_f32 v68, v68, v71
  v_add_f32 v76, v76, v79
  v_add_f32 v68, v68, v72
  v_add_f32 v76, v76, v80
  v_cvt_pk_bf16_f32 v68, v68, v68
  v_lshlrev_b32 v68, 16, v68
  v_cvt_pk_bf16_f32 v76, v76, v76
  v_lshlrev_b32 v76, 16, v76
  v_mul_f32 v69, 0xbfb8aa3b, v68
  v_exp_f32 v69, v69
  s_nop 0
  v_add_f32 v69, 1.0, v69
  v_rcp_f32 v70, v69
  s_nop 0
  v_mul_f32 v71, v68, v70
  v_fma_f32 v72, -v71, v69, v68
  v_fmac_f32 v71, v72, v70
  v_cvt_pk_bf16_f32 v71, v71, v71
  v_lshlrev_b32 v71, 16, v71
  v_mul_f32 v71, v71, v76
  v_cvt_pk_bf16_f32 v71, v71, v71
  v_lshlrev_b32 v71, 16, v71
  s_nop 0
  v_readlane_b32 s32, v71, 0
  v_readlane_b32 s33, v71, 1
  v_readlane_b32 s34, v71, 2
  v_readlane_b32 s35, v71, 3
  v_readlane_b32 s36, v71, 4
  v_readlane_b32 s37, v71, 5
  v_readlane_b32 s38, v71, 6
  v_readlane_b32 s39, v71, 7
  v_readlane_b32 s40, v71, 8
  v_readlane_b32 s41, v71, 9
  v_readlane_b32 s42, v71, 10
  v_readlane_b32 s43, v71, 11
  v_readlane_b32 s44, v71, 12
  v_readlane_b32 s45, v71, 13
  v_readlane_b32 s46, v71, 14
  v_readlane_b32 s47, v71, 15
  v_mov_b32 v84, 0
  v_mov_b32 v85, 0
  v_lshlrev_b32 v86, 16, v48
  v_and_b32 v87, 0xffff0000, v48
  v_fmac_f32 v84, s32, v86
  v_fmac_f32 v85, s32, v87
  v_lshlrev_b32 v86, 16, v49
  v_and_b32 v87, 0xffff0000, v49
  v_fmac_f32 v84, s33, v86
  v_fmac_f32 v85, s33, v87
  v_lshlrev_b32 v86, 16, v50
  v_and_b32 v87, 0xffff0000, v50
  v_fmac_f32 v84, s34, v86
  v_fmac_f32 v85, s34, v87
  v_lshlrev_b32 v86, 16, v51
  v_and_b32 v87, 0xffff0000, v51
  v_fmac_f32 v84, s35, v86
  v_fmac_f32 v85, s35, v87
  v_lshlrev_b32 v86, 16, v52
  v_and_b32 v87, 0xffff0000, v52
  v_fmac_f32 v84, s36, v86
  v_fmac_f32 v85, s36, v87
  v_lshlrev_b32 v86, 16, v53
  v_and_b32 v87, 0xffff0000, v53
  v_fmac_f32 v84, s37, v86
  v_fmac_f32 v85, s37, v87
  v_lshlrev_b32 v86, 16, v54
  v_and_b32 v87, 0xffff0000, v54
  v_fmac_f32 v84, s38, v86
  v_fmac_f32 v85, s38, v87
  v_lshlrev_b32 v86, 16, v55
  v_and_b32 v87, 0xffff0000, v55
  v_fmac_f32 v84, s39, v86
  v_fmac_f32 v85, s39, v87
  v_lshlrev_b32 v86, 16, v56
  v_and_b32 v87, 0xffff0000, v56
  v_fmac_f32 v84, s40, v86
  v_fmac_f32 v85, s40, v87
  v_lshlrev_b32 v86, 16, v57
  v_and_b32 v87, 0xffff0000, v57
  v_fmac_f32 v84, s41, v86
  v_fmac_f32 v85, s41, v87
  v_lshlrev_b32 v86, 16, v58
  v_and_b32 v87, 0xffff0000, v58
  v_fmac_f32 v84, s42, v86
  v_fmac_f32 v85, s42, v87
  v_lshlrev_b32 v86, 16, v59
  v_and_b32 v87, 0xffff0000, v59
  v_fmac_f32 v84, s43, v86
  v_fmac_f32 v85, s43, v87
  v_lshlrev_b32 v86, 16, v60
  v_and_b32 v87, 0xffff0000, v60
  v_fmac_f32 v84, s44, v86
  v_fmac_f32 v85, s44, v87
  v_lshlrev_b32 v86, 16, v61
  v_and_b32 v87, 0xffff0000, v61
  v_fmac_f32 v84, s45, v86
  v_fmac_f32 v85, s45, v87
  v_lshlrev_b32 v86, 16, v62
  v_and_b32 v87, 0xffff0000, v62
  v_fmac_f32 v84, s46, v86
  v_fmac_f32 v85, s46, v87
  v_lshlrev_b32 v86, 16, v63
  v_and_b32 v87, 0xffff0000, v63
  v_fmac_f32 v84, s47, v86
  v_fmac_f32 v85, s47, v87
  s_add_u32 s28, s6, 0x00600000
  s_addc_u32 s29, s7, 0
  s_mul_i32 s9, s2, 2560
  v_lshlrev_b32 v8, 3, v0
  v_add_u32 v8, s9, v8
  global_store_dwordx2 v8, v[84:85], s[28:29] sc1
  s_cmp_ge_u32 s2, 10
  s_cbranch_scc1 KB_END
  s_lshl_b32 s3, s2, 7
  s_add_u32 s3, s3, s24
  v_lshlrev_b32 v3, 1, v1
  v_add_u32 v3, s3, v3
  global_load_ushort v40, v3, s[20:21] sc1
  global_load_ushort v41, v3, s[20:21] offset:1280 sc1
  s_lshl_b32 s3, s2, 8
  s_mul_i32 s9, s8, 2560
  s_add_u32 s9, s9, s3
  v_lshlrev_b32 v5, 2, v1
  v_add_u32 v5, s9, v5
  s_mov_b32 s27, 0
KB4_PP:
  v_mov_b32 v2, v5
  v_mov_b32 v67, 0
  global_load_dword v48, v2, s[28:29] sc1
  v_add_u32 v2, 12800, v2
  global_load_dword v49, v2, s[28:29] sc1
  v_add_u32 v2, 12800, v2
  global_load_dword v50, v2, s[28:29] sc1
  v_add_u32 v2, 12800, v2
  global_load_dword v51, v2, s[28:29] sc1
  v_add_u32 v2, 12800, v2
  global_load_dword v52, v2, s[28:29] sc1
  v_add_u32 v2, 12800, v2
  global_load_dword v53, v2, s[28:29] sc1
  v_add_u32 v2, 12800, v2
  global_load_dword v54, v2, s[28:29] sc1
  v_add_u32 v2, 12800, v2
  global_load_dword v55, v2, s[28:29] sc1
  v_add_u32 v2, 12800, v2
  global_load_dword v56, v2, s[28:29] sc1
  v_add_u32 v2, 12800, v2
  global_load_dword v57, v2, s[28:29] sc1
  v_add_u32 v2, 12800, v2
  global_load_dword v58, v2, s[28:29] sc1
  v_add_u32 v2, 12800, v2
  global_load_dword v59, v2, s[28:29] sc1
  v_add_u32 v2, 12800, v2
  global_load_dword v60, v2, s[28:29] sc1
  v_add_u32 v2, 12800, v2
  global_load_dword v61, v2, s[28:29] sc1
  v_add_u32 v2, 12800, v2
  global_load_dword v62, v2, s[28:29] sc1
  v_add_u32 v2, 12800, v2
  global_load_dword v63, v2, s[28:29] sc1
  v_add_u32 v2, 12800, v2
  global_load_dword v64, v2, s[28:29] sc1
  v_add_u32 v2, 12800, v2
  global_load_dword v65, v2, s[28:29] sc1
  v_add_u32 v2, 12800, v2
  global_load_dword v66, v2, s[28:29] sc1
  v_add_u32 v2, 12800, v2
  s_cmp_lg_u32 s8, 0
  s_cbranch_scc1 KB4_NO20
  global_load_dword v67, v2, s[28:29] sc1
KB4_NO20:
  s_waitcnt vmcnt(0)
  v_max_u32 v6, v48, v49
  v_max3_u32 v6, v6, v50, v51
  v_max3_u32 v6, v6, v52, v53
  v_max3_u32 v6, v6, v54, v55
  v_max3_u32 v6, v6, v56, v57
  v_max3_u32 v6, v6, v58, v59
  v_max3_u32 v6, v6, v60, v61
  v_max3_u32 v6, v6, v62, v63
  v_max3_u32 v6, v6, v64, v65
  v_max3_u32 v6, v6, v66, v67
  v_cmp_eq_u32 vcc, -1, v6
  s_nop 0
  s_cmp_eq_u64 vcc, 0
  s_cbranch_scc1 KB4_PG
  s_add_u32 s27, s27, 1
  s_cmp_ge_u32 s27, 0x4000
  s_cbranch_scc1 KB4_PG
  s_sleep 4
  s_branch KB4_PP
KB4_PG:
  v_add_f32 v48, v48, v49
  v_add_f32 v48, v48, v50
  v_add_f32 v48, v48, v51
  v_add_f32 v48, v48, v52
  v_add_f32 v48, v48, v53
  v_add_f32 v48, v48, v54
  v_add_f32 v48, v48, v55
  v_add_f32 v48, v48, v56
  v_add_f32 v48, v48, v57
  v_add_f32 v48, v48, v58
  v_add_f32 v48, v48, v59
  v_add_f32 v48, v48, v60
  v_add_f32 v48, v48, v61
  v_add_f32 v48, v48, v62
  v_add_f32 v48, v48, v63
  v_add_f32 v48, v48, v64
  v_add_f32 v48, v48, v65
  v_add_f32 v48, v48, v66
  v_add_f32 v48, v48, v67
  v_lshlrev_b32 v4, 2, v0
  ds_write_b32 v4, v48 offset:2048
  s_waitcnt lgkmcnt(0)
  s_barrier
  s_cmp_lg_u32 s8, 0
  s_cbranch_scc1 KB_END
  ds_read_b32 v9, v4 offset:2304
  ds_read_b32 v10, v4 offset:2560
  ds_read_b32 v11, v4 offset:2816
  ds_read_b32 v12, v4 offset:3072
  s_waitcnt lgkmcnt(0)
  v_add_f32 v8, v48, v9
  v_add_f32 v10, v10, v11
  v_add_f32 v8, v8, v10
  v_add_f32 v8, v8, v12
  v_cvt_pk_bf16_f32 v8, v8, v8
  v_lshlrev_b32 v8, 16, v8
  s_lshr_b32 s25, s22, 16
  s_and_b32 s26, s25, 0x8000
  s_xor_b32 s27, s25, 0x8000
  s_not_b32 s14, s25
  s_and_b32 s14, s14, 0xffff
  s_cmp_lg_u32 s26, 0
  s_cselect_b32 s25, s27, s14
  s_lshl_b32 s25, s25, 16
  v_mov_b32 v12, s25
  v_mul_f32 v13, 0xbfb8aa3b, v12
  v_exp_f32 v13, v13
  s_nop 0
  v_add_f32 v13, 1.0, v13
  v_rcp_f32 v14, v13
  s_nop 0
  v_fma_f32 v15, -v14, v13, 1.0
  v_fmac_f32 v14, v15, v14
  v_cvt_pk_bf16_f32 v14, v14, v14
  v_lshlrev_b32 v14, 16, v14
  v_mul_f32 v8, v8, v14
  v_cvt_pk_bf16_f32 v8, v8, v8
  v_lshlrev_b32 v8, 16, v8
  v_lshlrev_b32 v40, 16, v40
  v_lshlrev_b32 v41, 16, v41
  v_add_f32 v8, v40, v8
  v_cvt_pk_bf16_f32 v8, v8, v8
  v_lshlrev_b32 v8, 16, v8
  v_add_f32 v8, v41, v8
  v_cvt_pk_bf16_f32 v8, v8, v8
  s_mul_i32 s25, s23, 1280
  s_lshl_b32 s3, s2, 7
  s_add_u32 s25, s25, s3
  v_lshlrev_b32 v3, 1, v1
  v_add_u32 v3, s25, v3
  global_store_short v3, v8, s[4:5] sc1
KB_END:
  s_endpgm
.section .rodata,"a"
.p2align 6
.amdhsa_kernel ka_kernel
  .amdhsa_next_free_vgpr 80
  .amdhsa_next_free_sgpr 102
  .amdhsa_accum_offset 80
  .amdhsa_group_segment_fixed_size 0
  .amdhsa_kernarg_size 136
  .amdhsa_user_sgpr_count 2
  .amdhsa_user_sgpr_kernarg_segment_ptr 1
  .amdhsa_system_sgpr_workgroup_id_x 1
.end_amdhsa_kernel

.p2align 6
.amdhsa_kernel kb_kernel
  .amdhsa_next_free_vgpr 108
  .amdhsa_next_free_sgpr 102
  .amdhsa_accum_offset 108
  .amdhsa_group_segment_fixed_size 0
  .amdhsa_kernarg_size 136
  .amdhsa_user_sgpr_count 2
  .amdhsa_user_sgpr_kernarg_segment_ptr 1
  .amdhsa_system_sgpr_workgroup_id_x 1
.end_amdhsa_kernel
```
